```python
import torch

def _softmax(x, axis=-1):
    return torch.softmax(x, dim=axis)
def _gelu(x):
    return torch.nn.functional.gelu(x, approximate="tanh")
def _silu(x):
    return torch.nn.functional.silu(x)
def _sigmoid(x):
    return torch.sigmoid(x)
def _layernorm(x, axis=-1, eps=1e-5):
    m = x.mean(dim=axis, keepdim=True)
    v = x.var(dim=axis, keepdim=True, unbiased=False)
    return (x - m) / torch.sqrt(v + eps)
def _scatter_add(tgt, idx, src, axis=0):
    return tgt.clone().index_add_(axis, idx, src)
def _segment_sum(src, seg, n):
    out = torch.zeros((n,) + src.shape[1:], dtype=src.dtype)
    return out.index_add_(0, seg, src)
def _pad(x, pw):
    flat = tuple(v for pair in reversed(pw) for v in pair)
    return torch.nn.functional.pad(x, flat)

kernel_name = 'parallel_sum__mha_block_cached__dense_activation_silu__decode'

def setup_inputs():

    _w = (lambda a: (lambda t: t.to(torch.bfloat16) if t.is_floating_point() else t)(torch.as_tensor(a)))
    def _A_setup():
        B, Sq, D = 4, 1, 512
        H, Sk, Dh = 32, 4096, 128
        return {
            "x": _w((lambda *s: torch.randn(*s, dtype=torch.bfloat16) * 0.05)(B, Sq, D)),
            "k_cache": _w((lambda *s: torch.randn(*s, dtype=torch.bfloat16) * 3.2)(B, H, Sk, Dh)),
            "v_cache": _w((lambda *s: torch.randn(*s, dtype=torch.bfloat16) * 0.8)(B, H, Sk, Dh)),
            "wq": _w((lambda *s: torch.randn(*s, dtype=torch.bfloat16) * 3.2)(D, H * Dh) * (D ** -0.5)),
            "wo": _w((lambda *s: torch.randn(*s, dtype=torch.bfloat16) * 0.8)(H * Dh, D) * ((H * Dh) ** -0.5)),
        }
    _A_in = _A_setup()

    def _B_setup():
        B, S, D, F = 4, 1, 512, 1792
        return {
            "x": _w((lambda *s: torch.randn(*s, dtype=torch.bfloat16) * 0.05)(B, S, D)),
            "w1": _w((lambda *s: torch.randn(*s, dtype=torch.bfloat16) * 3.2)(D, F) * (D ** -0.5)),
            "w2": _w((lambda *s: torch.randn(*s, dtype=torch.bfloat16) * 0.4)(F, D) * (F ** -0.5)),
        }
    _B_in = _B_setup()

    return {
        "A_x": _A_in["x"],
        "A_k_cache": _A_in["k_cache"],
        "A_v_cache": _A_in["v_cache"],
        "A_wq": _A_in["wq"],
        "A_wo": _A_in["wo"],
        "B_x": _B_in["x"],
        "B_w1": _B_in["w1"],
        "B_w2": _B_in["w2"],
    }

def reference(A_x, A_k_cache, A_v_cache, A_wq, A_wo, B_x, B_w1, B_w2):
    def _A_ref(x, k_cache, v_cache, wq, wo):
        B, Sq, D = x.shape
        H, Dh = 32, 128
        q = (lambda x, *d: x.permute(*d))((x @ wq).reshape(B, Sq, H, Dh), 0, 2, 1, 3)
        scores = torch.einsum("bhqd,bhkd->bhqk", q, k_cache) * (Dh ** -0.5)
        p = _softmax(scores, axis=-1)
        o = torch.einsum("bhqk,bhkd->bhqd", p, v_cache)
        return (lambda x, *d: x.permute(*d))(o, 0, 2, 1, 3).reshape(B, Sq, H * Dh) @ wo

    def _B_ref(x, w1, w2):
        h = torch.einsum("bsd,df->bsf", x, w1)
        h = _silu(h)
        out = torch.einsum("bsf,fd->bsd", h, w2)
        return out

    x = A_x
    xn = _layernorm(x, axis=-1)
    return x + _A_ref(xn, A_k_cache, A_v_cache, A_wq, A_wo) + _B_ref(xn, B_w1, B_w2)
```

```asm
; @launch grid=(256,1,1) block=(256,1,1) lds=8192
.amdgcn_target "amdgcn-amd-amdhsa--gfx950"
.text
.globl parallel_sum__mha_block_cached__dense_activation_silu__decode_kernel
.p2align 8
.type parallel_sum__mha_block_cached__dense_activation_silu__decode_kernel,@function
parallel_sum__mha_block_cached__dense_activation_silu__decode_kernel:
  s_cmp_ge_u32 s2, 256
  s_cbranch_scc1 L_end
  s_load_dwordx16 s[4:19], s[0:1], 0
  s_load_dwordx4 s[20:23], s[0:1], 64
  s_load_dwordx2 s[80:81], s[0:1], 80
  v_lshrrev_b32 v26, 6, v0
  v_and_b32 v1, 63, v0
  v_readfirstlane_b32 s64, v26
  s_and_b32 s68, s2, 7
  s_lshr_b32 s69, s2, 3
  s_lshr_b32 s74, s69, 3
  s_lshl_b32 s65, s68, 2
  s_add_u32 s65, s65, s74
  s_lshr_b32 s66, s69, 1
  s_and_b32 s66, s66, 3
  s_and_b32 s67, s69, 1
  s_lshl_b32 s70, s74, 1
  s_add_u32 s70, s70, s67
  s_lshr_b32 s75, s70, 2
  s_cmp_gt_u32 s70, 2
  s_cselect_b32 s76, 1, 0
  s_cmp_gt_u32 s70, 6
  s_cselect_b32 s75, 2, s76
  s_and_b32 s76, s70, 3
  s_cmp_eq_u32 s76, 2
  s_cselect_b32 s76, 16, 0
  s_sub_u32 s75, s70, s75
  s_add_u32 s75, s75, s76
  s_bitcmp1_b32 s68, 0
  s_cselect_b32 s70, s75, s70
  s_and_b32 s75, s74, s68
  s_and_b32 s75, s75, 1
  s_add_u32 s77, s75, 32
  s_sub_u32 s78, 64, s77
  s_cmp_eq_u32 s67, 0
  s_cselect_b32 s78, s77, s78
  s_cselect_b32 s77, 0, s77
  s_mov_b32 s72, s78
  s_mov_b32 s73, s77
  v_lshrrev_b32 v44, 4, v1
  v_and_b32 v45, 15, v1
  s_lshl_b32 s75, s66, 5
  s_add_u32 s75, s75, s65
  s_lshl_b32 s75, s75, 20
  s_lshl_b32 s76, s73, 14
  s_add_u32 s75, s75, s76
  s_lshl_b32 s76, s64, 10
  s_add_u32 s75, s75, s76
  v_lshlrev_b32 v9, 4, v1
  v_add_u32 v9, s75, v9
  s_lshl_b32 s75, s64, 20
  s_lshl_b32 s76, s65, 8
  s_add_u32 s75, s75, s76
  v_lshlrev_b32 v10, 18, v44
  v_lshl_add_u32 v10, v45, 4, v10
  v_add_u32 v10, s75, v10
  s_lshl_b32 s75, s66, 10
  v_lshlrev_b32 v46, 4, v1
  v_add_u32 v46, s75, v46
  s_lshl_b32 s76, s64, 8
  s_add_u32 s75, s75, s76
  v_lshlrev_b32 v47, 2, v1
  v_add_u32 v47, s75, v47
  s_lshl_b32 s75, s2, 10
  s_cmp_lt_u32 s2, 48
  s_cselect_b32 s75, s75, 1073741824
  s_cselect_b32 s76, 0, 1073741824
  s_cmp_eq_u32 s64, 0
  s_cselect_b32 s75, s75, 1073741824
  s_cselect_b32 s76, s76, 1073741824
  v_lshlrev_b32 v55, 4, v1
  v_add_u32 v55, s75, v55
  v_mov_b32 v53, s76
  v_mov_b32 v54, 1
  s_waitcnt lgkmcnt(0)
  s_mov_b32 s48, s4
  s_and_b32 s49, s5, 0xffff
  s_mov_b32 s50, 4096
  s_mov_b32 s51, 0x20000
  s_mov_b32 s32, s10
  s_and_b32 s33, s11, 0xffff
  s_mov_b32 s34, 4194304
  s_mov_b32 s35, 0x20000
  s_mov_b32 s24, s6
  s_and_b32 s25, s7, 0xffff
  s_mov_b32 s26, 134217728
  s_mov_b32 s27, 0x20000
  buffer_load_dwordx4 v[48:51], v46, s[48:51], 0 offen
  buffer_load_dword v52, v47, s[48:51], 0 offen
  s_mov_b32 s52, s80
  s_and_b32 s53, s81, 0xffff
  s_mov_b32 s54, 49152
  s_mov_b32 s55, 0x20000
  s_lshl_b32 s14, s72, 14
  s_cmp_lt_u32 s72, 33
  s_cselect_b32 s15, 1, 0
  s_cmp_lt_u32 s72, 32
  s_cselect_b32 s3, 1, 0
  s_mov_b32 s71, 0
  s_mov_b32 s72, s71
  s_mov_b32 s73, 0
  buffer_load_dwordx4 a[0:3], v10, s[32:35], s73 offen nt
  s_addk_i32 s73, 0x2000
  buffer_load_dwordx4 a[4:7], v10, s[32:35], s73 offen nt
  s_addk_i32 s73, 0x2000
  s_cmp_eq_u32 s15, 1
  s_cselect_b32 s78, 1073741824, s71
  buffer_load_dwordx4 v[128:131], v9, s[24:27], s78 offen nt
  s_cselect_b32 s78, 0, 0x1000
  s_add_u32 s71, s71, s78
  s_cmp_ge_u32 s71, s14
  s_cselect_b32 s71, 0, s71
  buffer_load_dwordx4 a[8:11], v10, s[32:35], s73 offen nt
  s_addk_i32 s73, 0x2000
  buffer_load_dwordx4 a[12:15], v10, s[32:35], s73 offen nt
  s_addk_i32 s73, 0x2000
  s_cmp_eq_u32 s15, 1
  s_cselect_b32 s78, 1073741824, s71
  buffer_load_dwordx4 v[132:135], v9, s[24:27], s78 offen nt
  s_cselect_b32 s78, 0, 0x1000
  s_add_u32 s71, s71, s78
  s_cmp_ge_u32 s71, s14
  s_cselect_b32 s71, 0, s71
  buffer_load_dwordx4 a[16:19], v10, s[32:35], s73 offen nt
  s_addk_i32 s73, 0x2000
  buffer_load_dwordx4 a[20:23], v10, s[32:35], s73 offen nt
  s_addk_i32 s73, 0x2000
  s_mov_b32 s28, s8
  s_and_b32 s29, s9, 0xffff
  s_mov_b32 s30, 134217728
  s_mov_b32 s31, 0x20000
  s_mov_b32 s36, s12
  s_and_b32 s37, s13, 0xffff
  s_mov_b32 s38, 4194304
  s_mov_b32 s39, 0x20000
  s_mov_b32 s40, s16
  s_and_b32 s41, s17, 0xffff
  s_mov_b32 s42, 1835008
  s_mov_b32 s43, 0x20000
  s_mov_b32 s44, s18
  s_and_b32 s45, s19, 0xffff
  s_mov_b32 s46, 1835008
  s_mov_b32 s47, 0x20000
  s_mov_b32 s60, s20
  s_and_b32 s61, s21, 0xffff
  s_mov_b32 s62, 4096
  s_mov_b32 s63, 0x20000
  s_mov_b32 s56, s22
  s_and_b32 s57, s23, 0xffff
  s_mov_b32 s58, 256
  s_mov_b32 s59, 0x20000
  s_cmp_eq_u32 s15, 1
  s_cselect_b32 s78, 1073741824, s71
  buffer_load_dwordx4 v[136:139], v9, s[24:27], s78 offen nt
  s_cselect_b32 s78, 0, 0x1000
  s_add_u32 s71, s71, s78
  s_cmp_ge_u32 s71, s14
  s_cselect_b32 s71, 0, s71
  buffer_load_dwordx4 a[24:27], v10, s[32:35], s73 offen nt
  s_addk_i32 s73, 0x2000
  buffer_load_dwordx4 a[28:31], v10, s[32:35], s73 offen nt
  s_addk_i32 s73, 0x2000
  s_cmp_eq_u32 s15, 1
  s_cselect_b32 s78, 1073741824, s71
  buffer_load_dwordx4 v[140:143], v9, s[24:27], s78 offen nt
  s_cselect_b32 s78, 0, 0x1000
  s_add_u32 s71, s71, s78
  s_cmp_ge_u32 s71, s14
  s_cselect_b32 s71, 0, s71
  buffer_load_dwordx4 a[32:35], v10, s[32:35], s73 offen nt
  s_addk_i32 s73, 0x2000
  buffer_load_dwordx4 a[36:39], v10, s[32:35], s73 offen nt
  s_addk_i32 s73, 0x2000
  s_cmp_eq_u32 s3, 1
  s_cselect_b32 s78, 1073741824, s71
  buffer_load_dwordx4 v[144:147], v9, s[24:27], s78 offen nt
  s_cselect_b32 s78, 0, 0x1000
  s_add_u32 s71, s71, s78
  s_cmp_ge_u32 s71, s14
  s_cselect_b32 s71, 0, s71
  buffer_load_dwordx4 a[40:43], v10, s[32:35], s73 offen nt
  s_addk_i32 s73, 0x2000
  s_cmp_ge_u32 s70, 16
  s_cselect_b32 s42, 0, s42
  s_cselect_b32 s46, 0, s46
  s_cselect_b32 s70, 0, s70
  s_lshr_b32 s75, s68, 1
  s_mul_i32 s75, s75, 14
  s_and_b32 s76, s68, 1
  s_lshl_b32 s76, s76, 3
  s_add_u32 s75, s75, s76
  s_add_u32 s75, s75, s70
  s_lshl_b32 s75, s75, 5
  s_mul_i32 s76, s64, 458752
  s_lshl_b32 s77, s75, 1
  s_add_u32 s76, s76, s77
  v_mul_u32_u24 v11, 114688, v44
  v_lshl_add_u32 v11, v45, 2, v11
  v_add_u32 v11, s76, v11
  s_lshl_b32 s76, s75, 10
  s_lshl_b32 s77, s64, 8
  s_add_u32 s76, s76, s77
  v_lshlrev_b32 v12, 13, v44
  v_lshl_add_u32 v12, v45, 4, v12
  v_add_u32 v12, s76, v12
  s_lshl_b32 s76, s65, 17
  s_add_u32 s76, s76, s77
  v_lshlrev_b32 v13, 15, v44
  v_lshl_add_u32 v13, v45, 4, v13
  v_add_u32 v13, s76, v13
  s_lshl_b32 s75, s66, 12
  s_lshl_b32 s76, s64, 10
  s_add_u32 s75, s75, s76
  v_lshlrev_b32 v60, 8, v44
  v_lshl_add_u32 v60, v45, 2, v60
  v_add_u32 v60, s75, v60
  s_lshl_b32 s75, s66, 10
  s_lshl_b32 s76, s64, 8
  s_add_u32 s75, s75, s76
  v_lshlrev_b32 v62, 6, v44
  v_lshl_add_u32 v62, v45, 1, v62
  v_add_u32 v62, s75, v62
  v_and_b32 v72, 1, v45
  v_cmp_eq_u32 vcc, 1, v72
  v_mov_b32 v72, 0xffff
  v_mov_b32 v73, 0xffff0000
  v_cndmask_b32 v72, v72, v73, vcc
  v_lshrrev_b32 v73, 1, v45
  v_cmp_eq_u32 vcc, 0, v73
  s_nop 1
  v_cndmask_b32 v2, 0, v72, vcc
  v_cmp_eq_u32 vcc, 1, v73
  s_nop 1
  v_cndmask_b32 v3, 0, v72, vcc
  v_cmp_eq_u32 vcc, 2, v73
  s_nop 1
  v_cndmask_b32 v4, 0, v72, vcc
  v_cmp_eq_u32 vcc, 3, v73
  s_nop 1
  v_cndmask_b32 v5, 0, v72, vcc
  v_cmp_gt_u32 vcc, 2, v45
  s_nop 1
  v_cndmask_b32 v6, 0, v72, vcc
  v_cmp_eq_u32 s[100:101], 8, v45
  s_mov_b32 s82, 0x3fb8aa3b
  s_waitcnt vmcnt(16)
  v_lshlrev_b32 v64, 16, v48
  v_and_b32 v65, 0xffff0000, v48
  v_lshlrev_b32 v66, 16, v49
  v_and_b32 v67, 0xffff0000, v49
  v_lshlrev_b32 v68, 16, v50
  v_and_b32 v69, 0xffff0000, v50
  v_lshlrev_b32 v70, 16, v51
  v_and_b32 v71, 0xffff0000, v51
  v_add_f32 v72, v64, v65
  v_add_f32 v73, v66, v67
  v_add_f32 v74, v68, v69
  v_add_f32 v75, v70, v71
  v_add_f32 v72, v72, v73
  v_add_f32 v74, v74, v75
  v_add_f32 v72, v72, v74
  buffer_load_dwordx4 a[44:47], v10, s[32:35], s73 offen nt
  s_addk_i32 s73, 0x2000
  s_nop 1
  v_add_f32_dpp v72, v72, v72 quad_perm:[1,0,3,2] row_mask:0xf bank_mask:0xf
  s_nop 1
  v_add_f32_dpp v72, v72, v72 quad_perm:[2,3,0,1] row_mask:0xf bank_mask:0xf
  s_nop 1
  v_add_f32_dpp v72, v72, v72 row_ror:4 row_mask:0xf bank_mask:0xf
  s_nop 1
  v_add_f32_dpp v72, v72, v72 row_ror:8 row_mask:0xf bank_mask:0xf
  s_nop 0
  v_readlane_b32 s74, v72, 0
  v_readlane_b32 s75, v72, 16
  v_readlane_b32 s76, v72, 32
  v_readlane_b32 s77, v72, 48
  s_nop 1
  v_mov_b32 v72, s74
  v_add_f32 v72, s75, v72
  v_add_f32 v72, s76, v72
  v_add_f32 v72, s77, v72
  s_cmp_eq_u32 s3, 1
  s_cselect_b32 s78, 1073741824, s71
  buffer_load_dwordx4 v[148:151], v9, s[24:27], s78 offen nt
  s_cselect_b32 s78, 0, 0x1000
  s_add_u32 s71, s71, s78
  s_cmp_ge_u32 s71, s14
  s_cselect_b32 s71, 0, s71
  v_mul_f32 v72, 0x3b000000, v72
  v_sub_f32 v64, v64, v72
  v_sub_f32 v65, v65, v72
  v_sub_f32 v66, v66, v72
  v_sub_f32 v67, v67, v72
  v_sub_f32 v68, v68, v72
  v_sub_f32 v69, v69, v72
  v_sub_f32 v70, v70, v72
  v_sub_f32 v71, v71, v72
  v_mul_f32 v73, v64, v64
  v_fmac_f32 v73, v65, v65
  v_fmac_f32 v73, v66, v66
  v_fmac_f32 v73, v67, v67
  v_fmac_f32 v73, v68, v68
  v_fmac_f32 v73, v69, v69
  v_fmac_f32 v73, v70, v70
  v_fmac_f32 v73, v71, v71
  buffer_load_dwordx4 a[48:51], v10, s[32:35], s73 offen nt
  s_addk_i32 s73, 0x2000
  s_nop 1
  v_add_f32_dpp v73, v73, v73 quad_perm:[1,0,3,2] row_mask:0xf bank_mask:0xf
  s_nop 1
  v_add_f32_dpp v73, v73, v73 quad_perm:[2,3,0,1] row_mask:0xf bank_mask:0xf
  s_nop 1
  v_add_f32_dpp v73, v73, v73 row_ror:4 row_mask:0xf bank_mask:0xf
  s_nop 1
  v_add_f32_dpp v73, v73, v73 row_ror:8 row_mask:0xf bank_mask:0xf
  s_nop 0
  v_readlane_b32 s74, v73, 0
  v_readlane_b32 s75, v73, 16
  v_readlane_b32 s76, v73, 32
  v_readlane_b32 s77, v73, 48
  s_nop 1
  v_mov_b32 v73, s74
  v_add_f32 v73, s75, v73
  v_add_f32 v73, s76, v73
  v_add_f32 v73, s77, v73
  buffer_load_dwordx4 a[52:55], v10, s[32:35], s73 offen nt
  s_addk_i32 s73, 0x2000
  v_mul_f32 v73, 0x3b000000, v73
  v_cvt_pk_bf16_f32 v74, v72, v72
  v_and_b32 v74, 0xffff0000, v74
  v_cvt_pk_bf16_f32 v73, v73, v73
  v_and_b32 v73, 0xffff0000, v73
  v_add_f32 v73, 0x3727c5ac, v73
  v_cvt_pk_bf16_f32 v73, v73, v73
  v_and_b32 v73, 0xffff0000, v73
  v_sqrt_f32 v75, v73
  s_nop 0
  v_cvt_pk_bf16_f32 v75, v75, v75
  v_and_b32 v75, 0xffff0000, v75
  v_rcp_f32 v76, v75
  s_cmp_eq_u32 s3, 1
  s_cselect_b32 s78, 1073741824, s71
  buffer_load_dwordx4 v[152:155], v9, s[24:27], s78 offen nt
  s_cselect_b32 s78, 0, 0x1000
  s_add_u32 s71, s71, s78
  s_cmp_ge_u32 s71, s14
  s_cselect_b32 s71, 0, s71
  v_lshlrev_b32 v77, 16, v52
  v_and_b32 v78, 0xffff0000, v52
  v_sub_f32 v77, v77, v74
  v_cvt_pk_bf16_f32 v77, v77, v77
  v_and_b32 v77, 0xffff0000, v77
  v_mul_f32 v79, v77, v76
  v_fma_f32 v80, -v79, v75, v77
  v_fma_f32 v79, v80, v76, v79
  v_cvt_pk_bf16_f32 v7, v79, v79
  v_sub_f32 v78, v78, v74
  v_cvt_pk_bf16_f32 v78, v78, v78
  v_and_b32 v78, 0xffff0000, v78
  v_mul_f32 v79, v78, v76
  v_fma_f32 v80, -v79, v75, v78
  v_fma_f32 v79, v80, v76, v79
  v_cvt_pk_bf16_f32 v8, v79, v79
  s_nop 1
  v_and_b32_dpp v28, v7, v2 row_newbcast:0 row_mask:0xf bank_mask:0xf
  v_and_b32_dpp v29, v7, v3 row_newbcast:0 row_mask:0xf bank_mask:0xf
  v_and_b32_dpp v30, v7, v4 row_newbcast:0 row_mask:0xf bank_mask:0xf
  v_and_b32_dpp v31, v7, v5 row_newbcast:0 row_mask:0xf bank_mask:0xf
  v_and_b32_dpp v32, v8, v2 row_newbcast:0 row_mask:0xf bank_mask:0xf
  v_and_b32_dpp v33, v8, v3 row_newbcast:0 row_mask:0xf bank_mask:0xf
  v_and_b32_dpp v34, v8, v4 row_newbcast:0 row_mask:0xf bank_mask:0xf
  v_and_b32_dpp v35, v8, v5 row_newbcast:0 row_mask:0xf bank_mask:0xf
  s_waitcnt vmcnt(20)
  v_mfma_f32_16x16x32_bf16 v[40:43], a[0:3], v[28:31], 0
  buffer_load_dwordx4 a[56:59], v10, s[32:35], s73 offen nt
  s_addk_i32 s73, 0x2000
  buffer_load_dwordx4 a[60:63], v10, s[32:35], s73 offen nt
  s_addk_i32 s73, 0x2000
  v_and_b32_dpp v28, v7, v2 row_newbcast:1 row_mask:0xf bank_mask:0xf
  v_and_b32_dpp v29, v7, v3 row_newbcast:1 row_mask:0xf bank_mask:0xf
  v_and_b32_dpp v30, v7, v4 row_newbcast:1 row_mask:0xf bank_mask:0xf
  v_and_b32_dpp v31, v7, v5 row_newbcast:1 row_mask:0xf bank_mask:0xf
  s_waitcnt vmcnt(21)
  v_mfma_f32_16x16x32_bf16 v[40:43], a[4:7], v[32:35], v[40:43]
  s_cmp_eq_u32 s3, 1
  s_cselect_b32 s78, 1073741824, s71
  buffer_load_dwordx4 v[156:159], v9, s[24:27], s78 offen nt
  s_cselect_b32 s78, 0, 0x1000
  s_add_u32 s71, s71, s78
  s_cmp_ge_u32 s71, s14
  s_cselect_b32 s71, 0, s71
  buffer_load_dwordx4 a[64:67], v10, s[32:35], s73 offen nt
  s_addk_i32 s73, 0x2000
  v_and_b32_dpp v32, v8, v2 row_newbcast:1 row_mask:0xf bank_mask:0xf
  v_and_b32_dpp v33, v8, v3 row_newbcast:1 row_mask:0xf bank_mask:0xf
  v_and_b32_dpp v34, v8, v4 row_newbcast:1 row_mask:0xf bank_mask:0xf
  v_and_b32_dpp v35, v8, v5 row_newbcast:1 row_mask:0xf bank_mask:0xf
  s_waitcnt vmcnt(21)
  v_mfma_f32_16x16x32_bf16 v[40:43], a[8:11], v[28:31], v[40:43]
  buffer_load_dwordx4 a[68:71], v10, s[32:35], s73 offen nt
  s_addk_i32 s73, 0x2000
  buffer_load_dwordx4 v[160:163], v9, s[24:27], s71 offen nt
  s_addk_i32 s71, 0x1000
  s_cmp_ge_u32 s71, s14
  s_cselect_b32 s71, 0, s71
  v_and_b32_dpp v28, v7, v2 row_newbcast:2 row_mask:0xf bank_mask:0xf
  v_and_b32_dpp v29, v7, v3 row_newbcast:2 row_mask:0xf bank_mask:0xf
  v_and_b32_dpp v30, v7, v4 row_newbcast:2 row_mask:0xf bank_mask:0xf
  v_and_b32_dpp v31, v7, v5 row_newbcast:2 row_mask:0xf bank_mask:0xf
  s_waitcnt vmcnt(22)
  v_mfma_f32_16x16x32_bf16 v[40:43], a[12:15], v[32:35], v[40:43]
  buffer_load_dwordx4 a[72:75], v10, s[32:35], s73 offen nt
  s_addk_i32 s73, 0x2000
  buffer_load_dwordx4 a[76:79], v10, s[32:35], s73 offen nt
  s_addk_i32 s73, 0x2000
  v_and_b32_dpp v32, v8, v2 row_newbcast:2 row_mask:0xf bank_mask:0xf
  v_and_b32_dpp v33, v8, v3 row_newbcast:2 row_mask:0xf bank_mask:0xf
  v_and_b32_dpp v34, v8, v4 row_newbcast:2 row_mask:0xf bank_mask:0xf
  v_and_b32_dpp v35, v8, v5 row_newbcast:2 row_mask:0xf bank_mask:0xf
  s_waitcnt vmcnt(22)
  v_mfma_f32_16x16x32_bf16 v[40:43], a[16:19], v[28:31], v[40:43]
  buffer_load_dwordx4 v[164:167], v9, s[24:27], s71 offen nt
  s_addk_i32 s71, 0x1000
  s_cmp_ge_u32 s71, s14
  s_cselect_b32 s71, 0, s71
  buffer_load_dwordx4 a[80:83], v10, s[32:35], s73 offen nt
  s_addk_i32 s73, 0x2000
  v_and_b32_dpp v28, v7, v2 row_newbcast:3 row_mask:0xf bank_mask:0xf
  v_and_b32_dpp v29, v7, v3 row_newbcast:3 row_mask:0xf bank_mask:0xf
  v_and_b32_dpp v30, v7, v4 row_newbcast:3 row_mask:0xf bank_mask:0xf
  v_and_b32_dpp v31, v7, v5 row_newbcast:3 row_mask:0xf bank_mask:0xf
  s_waitcnt vmcnt(23)
  v_mfma_f32_16x16x32_bf16 v[40:43], a[20:23], v[32:35], v[40:43]
  buffer_load_dwordx4 a[84:87], v10, s[32:35], s73 offen nt
  s_addk_i32 s73, 0x2000
  buffer_load_dwordx4 v[168:171], v9, s[24:27], s71 offen nt
  s_addk_i32 s71, 0x1000
  s_cmp_ge_u32 s71, s14
  s_cselect_b32 s71, 0, s71
  v_and_b32_dpp v32, v8, v2 row_newbcast:3 row_mask:0xf bank_mask:0xf
  v_and_b32_dpp v33, v8, v3 row_newbcast:3 row_mask:0xf bank_mask:0xf
  v_and_b32_dpp v34, v8, v4 row_newbcast:3 row_mask:0xf bank_mask:0xf
  v_and_b32_dpp v35, v8, v5 row_newbcast:3 row_mask:0xf bank_mask:0xf
  s_waitcnt vmcnt(23)
  v_mfma_f32_16x16x32_bf16 v[40:43], a[24:27], v[28:31], v[40:43]
  buffer_load_dwordx4 a[88:91], v10, s[32:35], s73 offen nt
  s_addk_i32 s73, 0x2000
  buffer_load_dwordx4 a[92:95], v10, s[32:35], s73 offen nt
  s_addk_i32 s73, 0x2000
  v_and_b32_dpp v28, v7, v2 row_newbcast:4 row_mask:0xf bank_mask:0xf
  v_and_b32_dpp v29, v7, v3 row_newbcast:4 row_mask:0xf bank_mask:0xf
  v_and_b32_dpp v30, v7, v4 row_newbcast:4 row_mask:0xf bank_mask:0xf
  v_and_b32_dpp v31, v7, v5 row_newbcast:4 row_mask:0xf bank_mask:0xf
  s_waitcnt vmcnt(24)
  v_mfma_f32_16x16x32_bf16 v[40:43], a[28:31], v[32:35], v[40:43]
  buffer_load_dwordx4 v[172:175], v9, s[24:27], s71 offen nt
  s_addk_i32 s71, 0x1000
  s_cmp_ge_u32 s71, s14
  s_cselect_b32 s71, 0, s71
  buffer_load_dwordx4 a[96:99], v10, s[32:35], s73 offen nt
  s_addk_i32 s73, 0x2000
  v_and_b32_dpp v32, v8, v2 row_newbcast:4 row_mask:0xf bank_mask:0xf
  v_and_b32_dpp v33, v8, v3 row_newbcast:4 row_mask:0xf bank_mask:0xf
  v_and_b32_dpp v34, v8, v4 row_newbcast:4 row_mask:0xf bank_mask:0xf
  v_and_b32_dpp v35, v8, v5 row_newbcast:4 row_mask:0xf bank_mask:0xf
  s_waitcnt vmcnt(24)
  v_mfma_f32_16x16x32_bf16 v[40:43], a[32:35], v[28:31], v[40:43]
  buffer_load_dwordx4 a[100:103], v10, s[32:35], s73 offen nt
  s_addk_i32 s73, 0x2000
  buffer_load_dwordx4 v[176:179], v9, s[24:27], s71 offen nt
  s_addk_i32 s71, 0x1000
  s_cmp_ge_u32 s71, s14
  s_cselect_b32 s71, 0, s71
  v_and_b32_dpp v28, v7, v2 row_newbcast:5 row_mask:0xf bank_mask:0xf
  v_and_b32_dpp v29, v7, v3 row_newbcast:5 row_mask:0xf bank_mask:0xf
  v_and_b32_dpp v30, v7, v4 row_newbcast:5 row_mask:0xf bank_mask:0xf
  v_and_b32_dpp v31, v7, v5 row_newbcast:5 row_mask:0xf bank_mask:0xf
  s_waitcnt vmcnt(25)
  v_mfma_f32_16x16x32_bf16 v[40:43], a[36:39], v[32:35], v[40:43]
  buffer_load_dwordx4 a[104:107], v10, s[32:35], s73 offen nt
  s_addk_i32 s73, 0x2000
  buffer_load_dwordx4 a[108:111], v10, s[32:35], s73 offen nt
  s_addk_i32 s73, 0x2000
  v_and_b32_dpp v32, v8, v2 row_newbcast:5 row_mask:0xf bank_mask:0xf
  v_and_b32_dpp v33, v8, v3 row_newbcast:5 row_mask:0xf bank_mask:0xf
  v_and_b32_dpp v34, v8, v4 row_newbcast:5 row_mask:0xf bank_mask:0xf
  v_and_b32_dpp v35, v8, v5 row_newbcast:5 row_mask:0xf bank_mask:0xf
  s_waitcnt vmcnt(25)
  v_mfma_f32_16x16x32_bf16 v[40:43], a[40:43], v[28:31], v[40:43]
  buffer_load_dwordx4 v[180:183], v9, s[24:27], s71 offen nt
  s_addk_i32 s71, 0x1000
  s_cmp_ge_u32 s71, s14
  s_cselect_b32 s71, 0, s71
  buffer_load_dwordx4 a[112:115], v10, s[32:35], s73 offen nt
  s_addk_i32 s73, 0x2000
  v_and_b32_dpp v28, v7, v2 row_newbcast:6 row_mask:0xf bank_mask:0xf
  v_and_b32_dpp v29, v7, v3 row_newbcast:6 row_mask:0xf bank_mask:0xf
  v_and_b32_dpp v30, v7, v4 row_newbcast:6 row_mask:0xf bank_mask:0xf
  v_and_b32_dpp v31, v7, v5 row_newbcast:6 row_mask:0xf bank_mask:0xf
  s_waitcnt vmcnt(26)
  v_mfma_f32_16x16x32_bf16 v[40:43], a[44:47], v[32:35], v[40:43]
  buffer_load_dwordx4 a[116:119], v10, s[32:35], s73 offen nt
  s_addk_i32 s73, 0x2000
  buffer_load_dwordx4 v[184:187], v9, s[24:27], s71 offen nt
  s_addk_i32 s71, 0x1000
  s_cmp_ge_u32 s71, s14
  s_cselect_b32 s71, 0, s71
  v_and_b32_dpp v32, v8, v2 row_newbcast:6 row_mask:0xf bank_mask:0xf
  v_and_b32_dpp v33, v8, v3 row_newbcast:6 row_mask:0xf bank_mask:0xf
  v_and_b32_dpp v34, v8, v4 row_newbcast:6 row_mask:0xf bank_mask:0xf
  v_and_b32_dpp v35, v8, v5 row_newbcast:6 row_mask:0xf bank_mask:0xf
  s_waitcnt vmcnt(26)
  v_mfma_f32_16x16x32_bf16 v[40:43], a[48:51], v[28:31], v[40:43]
  buffer_load_dwordx4 a[120:123], v10, s[32:35], s73 offen nt
  s_addk_i32 s73, 0x2000
  buffer_load_dwordx4 a[124:127], v10, s[32:35], s73 offen nt
  s_addk_i32 s73, 0x2000
  v_and_b32_dpp v28, v7, v2 row_newbcast:7 row_mask:0xf bank_mask:0xf
  v_and_b32_dpp v29, v7, v3 row_newbcast:7 row_mask:0xf bank_mask:0xf
  v_and_b32_dpp v30, v7, v4 row_newbcast:7 row_mask:0xf bank_mask:0xf
  v_and_b32_dpp v31, v7, v5 row_newbcast:7 row_mask:0xf bank_mask:0xf
  s_waitcnt vmcnt(27)
  v_mfma_f32_16x16x32_bf16 v[40:43], a[52:55], v[32:35], v[40:43]
  buffer_load_dwordx4 v[188:191], v9, s[24:27], s71 offen nt
  s_addk_i32 s71, 0x1000
  s_cmp_ge_u32 s71, s14
  s_cselect_b32 s71, 0, s71
  buffer_load_dwordx4 v[192:195], v9, s[24:27], s71 offen nt
  s_addk_i32 s71, 0x1000
  s_cmp_ge_u32 s71, s14
  s_cselect_b32 s71, 0, s71
  v_and_b32_dpp v32, v8, v2 row_newbcast:7 row_mask:0xf bank_mask:0xf
  v_and_b32_dpp v33, v8, v3 row_newbcast:7 row_mask:0xf bank_mask:0xf
  v_and_b32_dpp v34, v8, v4 row_newbcast:7 row_mask:0xf bank_mask:0xf
  v_and_b32_dpp v35, v8, v5 row_newbcast:7 row_mask:0xf bank_mask:0xf
  s_waitcnt vmcnt(27)
  v_mfma_f32_16x16x32_bf16 v[40:43], a[56:59], v[28:31], v[40:43]
  buffer_load_dwordx4 v[196:199], v9, s[24:27], s71 offen nt
  s_addk_i32 s71, 0x1000
  s_cmp_ge_u32 s71, s14
  s_cselect_b32 s71, 0, s71
  buffer_load_dwordx4 v[200:203], v9, s[24:27], s71 offen nt
  s_addk_i32 s71, 0x1000
  s_cmp_ge_u32 s71, s14
  s_cselect_b32 s71, 0, s71
  v_and_b32_dpp v28, v7, v2 row_newbcast:8 row_mask:0xf bank_mask:0xf
  v_and_b32_dpp v29, v7, v3 row_newbcast:8 row_mask:0xf bank_mask:0xf
  v_and_b32_dpp v30, v7, v4 row_newbcast:8 row_mask:0xf bank_mask:0xf
  v_and_b32_dpp v31, v7, v5 row_newbcast:8 row_mask:0xf bank_mask:0xf
  s_waitcnt vmcnt(28)
  v_mfma_f32_16x16x32_bf16 v[40:43], a[60:63], v[32:35], v[40:43]
  buffer_load_dwordx4 v[204:207], v9, s[24:27], s71 offen nt
  s_addk_i32 s71, 0x1000
  s_cmp_ge_u32 s71, s14
  s_cselect_b32 s71, 0, s71
  buffer_load_dwordx4 v[208:211], v9, s[24:27], s71 offen nt
  s_addk_i32 s71, 0x1000
  s_cmp_ge_u32 s71, s14
  s_cselect_b32 s71, 0, s71
  v_and_b32_dpp v32, v8, v2 row_newbcast:8 row_mask:0xf bank_mask:0xf
  v_and_b32_dpp v33, v8, v3 row_newbcast:8 row_mask:0xf bank_mask:0xf
  v_and_b32_dpp v34, v8, v4 row_newbcast:8 row_mask:0xf bank_mask:0xf
  v_and_b32_dpp v35, v8, v5 row_newbcast:8 row_mask:0xf bank_mask:0xf
  s_waitcnt vmcnt(28)
  v_mfma_f32_16x16x32_bf16 v[40:43], a[64:67], v[28:31], v[40:43]
  buffer_load_dwordx4 v[212:215], v9, s[24:27], s71 offen nt
  s_addk_i32 s71, 0x1000
  s_cmp_ge_u32 s71, s14
  s_cselect_b32 s71, 0, s71
  buffer_load_dwordx4 v[216:219], v9, s[24:27], s71 offen nt
  s_addk_i32 s71, 0x1000
  s_cmp_ge_u32 s71, s14
  s_cselect_b32 s71, 0, s71
  v_and_b32_dpp v28, v7, v2 row_newbcast:9 row_mask:0xf bank_mask:0xf
  v_and_b32_dpp v29, v7, v3 row_newbcast:9 row_mask:0xf bank_mask:0xf
  v_and_b32_dpp v30, v7, v4 row_newbcast:9 row_mask:0xf bank_mask:0xf
  v_and_b32_dpp v31, v7, v5 row_newbcast:9 row_mask:0xf bank_mask:0xf
  s_waitcnt vmcnt(29)
  v_mfma_f32_16x16x32_bf16 v[40:43], a[68:71], v[32:35], v[40:43]
  buffer_load_dwordx4 v[220:223], v9, s[24:27], s71 offen nt
  s_addk_i32 s71, 0x1000
  s_cmp_ge_u32 s71, s14
  s_cselect_b32 s71, 0, s71
  v_and_b32_dpp v32, v8, v2 row_newbcast:9 row_mask:0xf bank_mask:0xf
  v_and_b32_dpp v33, v8, v3 row_newbcast:9 row_mask:0xf bank_mask:0xf
  v_and_b32_dpp v34, v8, v4 row_newbcast:9 row_mask:0xf bank_mask:0xf
  v_and_b32_dpp v35, v8, v5 row_newbcast:9 row_mask:0xf bank_mask:0xf
  s_waitcnt vmcnt(28)
  v_mfma_f32_16x16x32_bf16 v[40:43], a[72:75], v[28:31], v[40:43]
  v_and_b32_dpp v28, v7, v2 row_newbcast:10 row_mask:0xf bank_mask:0xf
  v_and_b32_dpp v29, v7, v3 row_newbcast:10 row_mask:0xf bank_mask:0xf
  v_and_b32_dpp v30, v7, v4 row_newbcast:10 row_mask:0xf bank_mask:0xf
  v_and_b32_dpp v31, v7, v5 row_newbcast:10 row_mask:0xf bank_mask:0xf
  s_waitcnt vmcnt(27)
  v_mfma_f32_16x16x32_bf16 v[40:43], a[76:79], v[32:35], v[40:43]
  v_and_b32_dpp v32, v8, v2 row_newbcast:10 row_mask:0xf bank_mask:0xf
  v_and_b32_dpp v33, v8, v3 row_newbcast:10 row_mask:0xf bank_mask:0xf
  v_and_b32_dpp v34, v8, v4 row_newbcast:10 row_mask:0xf bank_mask:0xf
  v_and_b32_dpp v35, v8, v5 row_newbcast:10 row_mask:0xf bank_mask:0xf
  s_waitcnt vmcnt(25)
  v_mfma_f32_16x16x32_bf16 v[40:43], a[80:83], v[28:31], v[40:43]
  v_and_b32_dpp v28, v7, v2 row_newbcast:11 row_mask:0xf bank_mask:0xf
  v_and_b32_dpp v29, v7, v3 row_newbcast:11 row_mask:0xf bank_mask:0xf
  v_and_b32_dpp v30, v7, v4 row_newbcast:11 row_mask:0xf bank_mask:0xf
  v_and_b32_dpp v31, v7, v5 row_newbcast:11 row_mask:0xf bank_mask:0xf
  s_waitcnt vmcnt(24)
  v_mfma_f32_16x16x32_bf16 v[40:43], a[84:87], v[32:35], v[40:43]
  v_and_b32_dpp v32, v8, v2 row_newbcast:11 row_mask:0xf bank_mask:0xf
  v_and_b32_dpp v33, v8, v3 row_newbcast:11 row_mask:0xf bank_mask:0xf
  v_and_b32_dpp v34, v8, v4 row_newbcast:11 row_mask:0xf bank_mask:0xf
  v_and_b32_dpp v35, v8, v5 row_newbcast:11 row_mask:0xf bank_mask:0xf
  s_waitcnt vmcnt(22)
  v_mfma_f32_16x16x32_bf16 v[40:43], a[88:91], v[28:31], v[40:43]
  v_and_b32_dpp v28, v7, v2 row_newbcast:12 row_mask:0xf bank_mask:0xf
  v_and_b32_dpp v29, v7, v3 row_newbcast:12 row_mask:0xf bank_mask:0xf
  v_and_b32_dpp v30, v7, v4 row_newbcast:12 row_mask:0xf bank_mask:0xf
  v_and_b32_dpp v31, v7, v5 row_newbcast:12 row_mask:0xf bank_mask:0xf
  s_waitcnt vmcnt(21)
  v_mfma_f32_16x16x32_bf16 v[40:43], a[92:95], v[32:35], v[40:43]
  v_and_b32_dpp v32, v8, v2 row_newbcast:12 row_mask:0xf bank_mask:0xf
  v_and_b32_dpp v33, v8, v3 row_newbcast:12 row_mask:0xf bank_mask:0xf
  v_and_b32_dpp v34, v8, v4 row_newbcast:12 row_mask:0xf bank_mask:0xf
  v_and_b32_dpp v35, v8, v5 row_newbcast:12 row_mask:0xf bank_mask:0xf
  s_waitcnt vmcnt(19)
  v_mfma_f32_16x16x32_bf16 v[40:43], a[96:99], v[28:31], v[40:43]
  v_and_b32_dpp v28, v7, v2 row_newbcast:13 row_mask:0xf bank_mask:0xf
  v_and_b32_dpp v29, v7, v3 row_newbcast:13 row_mask:0xf bank_mask:0xf
  v_and_b32_dpp v30, v7, v4 row_newbcast:13 row_mask:0xf bank_mask:0xf
  v_and_b32_dpp v31, v7, v5 row_newbcast:13 row_mask:0xf bank_mask:0xf
  s_waitcnt vmcnt(18)
  v_mfma_f32_16x16x32_bf16 v[40:43], a[100:103], v[32:35], v[40:43]
  v_and_b32_dpp v32, v8, v2 row_newbcast:13 row_mask:0xf bank_mask:0xf
  v_and_b32_dpp v33, v8, v3 row_newbcast:13 row_mask:0xf bank_mask:0xf
  v_and_b32_dpp v34, v8, v4 row_newbcast:13 row_mask:0xf bank_mask:0xf
  v_and_b32_dpp v35, v8, v5 row_newbcast:13 row_mask:0xf bank_mask:0xf
  s_waitcnt vmcnt(16)
  v_mfma_f32_16x16x32_bf16 v[40:43], a[104:107], v[28:31], v[40:43]
  v_and_b32_dpp v28, v7, v2 row_newbcast:14 row_mask:0xf bank_mask:0xf
  v_and_b32_dpp v29, v7, v3 row_newbcast:14 row_mask:0xf bank_mask:0xf
  v_and_b32_dpp v30, v7, v4 row_newbcast:14 row_mask:0xf bank_mask:0xf
  v_and_b32_dpp v31, v7, v5 row_newbcast:14 row_mask:0xf bank_mask:0xf
  s_waitcnt vmcnt(15)
  v_mfma_f32_16x16x32_bf16 v[40:43], a[108:111], v[32:35], v[40:43]
  v_and_b32_dpp v32, v8, v2 row_newbcast:14 row_mask:0xf bank_mask:0xf
  v_and_b32_dpp v33, v8, v3 row_newbcast:14 row_mask:0xf bank_mask:0xf
  v_and_b32_dpp v34, v8, v4 row_newbcast:14 row_mask:0xf bank_mask:0xf
  v_and_b32_dpp v35, v8, v5 row_newbcast:14 row_mask:0xf bank_mask:0xf
  s_waitcnt vmcnt(13)
  v_mfma_f32_16x16x32_bf16 v[40:43], a[112:115], v[28:31], v[40:43]
  v_and_b32_dpp v28, v7, v2 row_newbcast:15 row_mask:0xf bank_mask:0xf
  v_and_b32_dpp v29, v7, v3 row_newbcast:15 row_mask:0xf bank_mask:0xf
  v_and_b32_dpp v30, v7, v4 row_newbcast:15 row_mask:0xf bank_mask:0xf
  v_and_b32_dpp v31, v7, v5 row_newbcast:15 row_mask:0xf bank_mask:0xf
  s_waitcnt vmcnt(12)
  v_mfma_f32_16x16x32_bf16 v[40:43], a[116:119], v[32:35], v[40:43]
  v_and_b32_dpp v32, v8, v2 row_newbcast:15 row_mask:0xf bank_mask:0xf
  v_and_b32_dpp v33, v8, v3 row_newbcast:15 row_mask:0xf bank_mask:0xf
  v_and_b32_dpp v34, v8, v4 row_newbcast:15 row_mask:0xf bank_mask:0xf
  v_and_b32_dpp v35, v8, v5 row_newbcast:15 row_mask:0xf bank_mask:0xf
  s_waitcnt vmcnt(10)
  v_mfma_f32_16x16x32_bf16 v[40:43], a[120:123], v[28:31], v[40:43]
  s_nop 1
  s_waitcnt vmcnt(9)
  v_mfma_f32_16x16x32_bf16 v[40:43], a[124:127], v[32:35], v[40:43]
  s_nop 7
  s_lshl_b32 s74, s64, 9
  v_lshlrev_b32 v56, 7, v44
  v_lshl_add_u32 v56, v45, 2, v56
  v_add_u32 v56, s74, v56
  s_mov_b32 exec_lo, 0x00ff00ff
  s_mov_b32 exec_hi, 0x00ff00ff
  ds_write_b32 v56, v40 offset:0
  ds_write_b32 v56, v41 offset:32
  ds_write_b32 v56, v42 offset:64
  ds_write_b32 v56, v43 offset:96
  s_mov_b64 exec, -1
  v_lshlrev_b32 v57, 5, v45
  s_waitcnt lgkmcnt(0)
  s_barrier
  ds_read_b128 v[64:67], v57 offset:0
  ds_read_b128 v[68:71], v57 offset:16
  ds_read_b128 v[72:75], v57 offset:512
  ds_read_b128 v[76:79], v57 offset:528
  ds_read_b128 v[80:83], v57 offset:1024
  ds_read_b128 v[84:87], v57 offset:1040
  ds_read_b128 v[88:91], v57 offset:1536
  ds_read_b128 v[92:95], v57 offset:1552
  s_waitcnt lgkmcnt(0)
  v_add_f32 v64, v64, v72
  v_add_f32 v80, v80, v88
  v_add_f32 v65, v65, v73
  v_add_f32 v81, v81, v89
  v_add_f32 v66, v66, v74
  v_add_f32 v82, v82, v90
  v_add_f32 v67, v67, v75
  v_add_f32 v83, v83, v91
  v_add_f32 v68, v68, v76
  v_add_f32 v84, v84, v92
  v_add_f32 v69, v69, v77
  v_add_f32 v85, v85, v93
  v_add_f32 v70, v70, v78
  v_add_f32 v86, v86, v94
  v_add_f32 v71, v71, v79
  v_add_f32 v87, v87, v95
  v_add_f32 v64, v64, v80
  v_add_f32 v65, v65, v81
  v_add_f32 v66, v66, v82
  v_add_f32 v67, v67, v83
  v_add_f32 v68, v68, v84
  v_add_f32 v69, v69, v85
  v_add_f32 v70, v70, v86
  v_add_f32 v71, v71, v87
  v_cvt_pk_bf16_f32 v14, v64, v65
  v_cvt_pk_bf16_f32 v15, v66, v67
  v_cvt_pk_bf16_f32 v16, v68, v69
  v_cvt_pk_bf16_f32 v17, v70, v71
  buffer_load_dwordx4 v[224:227], v9, s[24:27], s71 offen nt
  s_addk_i32 s71, 0x1000
  s_cmp_ge_u32 s71, s14
  s_cselect_b32 s71, 0, s71
  buffer_load_dwordx4 v[228:231], v9, s[24:27], s71 offen nt
  s_addk_i32 s71, 0x1000
  s_cmp_ge_u32 s71, s14
  s_cselect_b32 s71, 0, s71
  buffer_load_dwordx4 v[232:235], v9, s[24:27], s71 offen nt
  s_addk_i32 s71, 0x1000
  s_cmp_ge_u32 s71, s14
  s_cselect_b32 s71, 0, s71
  buffer_load_dwordx4 v[236:239], v9, s[24:27], s71 offen nt
  s_addk_i32 s71, 0x1000
  s_cmp_ge_u32 s71, s14
  s_cselect_b32 s71, 0, s71
  buffer_load_dwordx4 v[240:243], v9, s[24:27], s71 offen nt
  s_addk_i32 s71, 0x1000
  s_cmp_ge_u32 s71, s14
  s_cselect_b32 s71, 0, s71
  buffer_load_dwordx4 v[244:247], v9, s[24:27], s71 offen nt
  s_addk_i32 s71, 0x1000
  s_cmp_ge_u32 s71, s14
  s_cselect_b32 s71, 0, s71
  buffer_load_dwordx4 v[248:251], v9, s[24:27], s71 offen nt
  s_addk_i32 s71, 0x1000
  s_cmp_ge_u32 s71, s14
  s_cselect_b32 s71, 0, s71
  buffer_load_dwordx4 v[252:255], v9, s[24:27], s71 offen nt
  s_addk_i32 s71, 0x1000
  s_cmp_ge_u32 s71, s14
  s_cselect_b32 s71, 0, s71
  s_cmp_eq_u32 s15, 1
  s_cselect_b32 s78, 1073741824, s72
  buffer_load_dwordx4 a[192:195], v9, s[28:31], s78 offen nt
  s_cselect_b32 s78, 0, 0x1000
  s_add_u32 s72, s72, s78
  s_cmp_ge_u32 s72, s14
  s_cselect_b32 s72, 0, s72
  s_cmp_eq_u32 s15, 1
  s_cselect_b32 s78, 1073741824, s72
  buffer_load_dwordx4 a[196:199], v9, s[28:31], s78 offen nt
  s_cselect_b32 s78, 0, 0x1000
  s_add_u32 s72, s72, s78
  s_cmp_ge_u32 s72, s14
  s_cselect_b32 s72, 0, s72
  s_cmp_eq_u32 s15, 1
  s_cselect_b32 s78, 1073741824, s72
  buffer_load_dwordx4 a[200:203], v9, s[28:31], s78 offen nt
  s_cselect_b32 s78, 0, 0x1000
  s_add_u32 s72, s72, s78
  s_cmp_ge_u32 s72, s14
  s_cselect_b32 s72, 0, s72
  s_cmp_eq_u32 s15, 1
  s_cselect_b32 s78, 1073741824, s72
  buffer_load_dwordx4 a[204:207], v9, s[28:31], s78 offen nt
  s_cselect_b32 s78, 0, 0x1000
  s_add_u32 s72, s72, s78
  s_cmp_ge_u32 s72, s14
  s_cselect_b32 s72, 0, s72
  s_cmp_eq_u32 s3, 1
  s_cselect_b32 s78, 1073741824, s72
  buffer_load_dwordx4 a[208:211], v9, s[28:31], s78 offen nt
  s_cselect_b32 s78, 0, 0x1000
  s_add_u32 s72, s72, s78
  s_cmp_ge_u32 s72, s14
  s_cselect_b32 s72, 0, s72
  s_cmp_eq_u32 s3, 1
  s_cselect_b32 s78, 1073741824, s72
  buffer_load_dwordx4 a[212:215], v9, s[28:31], s78 offen nt
  s_cselect_b32 s78, 0, 0x1000
  s_add_u32 s72, s72, s78
  s_cmp_ge_u32 s72, s14
  s_cselect_b32 s72, 0, s72
  s_cmp_eq_u32 s3, 1
  s_cselect_b32 s78, 1073741824, s72
  buffer_load_dwordx4 a[216:219], v9, s[28:31], s78 offen nt
  s_cselect_b32 s78, 0, 0x1000
  s_add_u32 s72, s72, s78
  s_cmp_ge_u32 s72, s14
  s_cselect_b32 s72, 0, s72
  s_cmp_eq_u32 s3, 1
  s_cselect_b32 s78, 1073741824, s72
  buffer_load_dwordx4 a[220:223], v9, s[28:31], s78 offen nt
  s_cselect_b32 s78, 0, 0x1000
  s_add_u32 s72, s72, s78
  s_cmp_ge_u32 s72, s14
  s_cselect_b32 s72, 0, s72
  buffer_load_dwordx4 a[224:227], v9, s[28:31], s72 offen nt
  s_addk_i32 s72, 0x1000
  s_cmp_ge_u32 s72, s14
  s_cselect_b32 s72, 0, s72
  buffer_load_dwordx4 a[228:231], v9, s[28:31], s72 offen nt
  s_addk_i32 s72, 0x1000
  s_cmp_ge_u32 s72, s14
  s_cselect_b32 s72, 0, s72
  buffer_load_dwordx4 a[232:235], v9, s[28:31], s72 offen nt
  s_addk_i32 s72, 0x1000
  s_cmp_ge_u32 s72, s14
  s_cselect_b32 s72, 0, s72
  buffer_load_dwordx4 a[236:239], v9, s[28:31], s72 offen nt
  s_addk_i32 s72, 0x1000
  s_cmp_ge_u32 s72, s14
  s_cselect_b32 s72, 0, s72
  buffer_load_dwordx4 a[240:243], v9, s[28:31], s72 offen nt
  s_addk_i32 s72, 0x1000
  s_cmp_ge_u32 s72, s14
  s_cselect_b32 s72, 0, s72
  buffer_load_dwordx4 a[244:247], v9, s[28:31], s72 offen nt
  s_addk_i32 s72, 0x1000
  s_cmp_ge_u32 s72, s14
  s_cselect_b32 s72, 0, s72
  buffer_load_dwordx4 a[248:251], v9, s[28:31], s72 offen nt
  s_addk_i32 s72, 0x1000
  s_cmp_ge_u32 s72, s14
  s_cselect_b32 s72, 0, s72
  buffer_load_dwordx4 a[252:255], v9, s[28:31], s72 offen nt
  s_addk_i32 s72, 0x1000
  s_cmp_ge_u32 s72, s14
  s_cselect_b32 s72, 0, s72
  v_mov_b32 v24, 0xff800000
  v_dot2_f32_bf16 v18, v128, v14, 0
  v_dot2_f32_bf16 v19, v132, v14, 0
  v_dot2_f32_bf16 v20, v136, v14, 0
  v_dot2_f32_bf16 v21, v140, v14, 0
  v_dot2c_f32_bf16 v18, v129, v15
  v_dot2c_f32_bf16 v19, v133, v15
  v_dot2c_f32_bf16 v20, v137, v15
  v_dot2c_f32_bf16 v21, v141, v15
  v_dot2c_f32_bf16 v18, v130, v16
  v_dot2c_f32_bf16 v19, v134, v16
  v_dot2c_f32_bf16 v20, v138, v16
  v_dot2c_f32_bf16 v21, v142, v16
  v_dot2c_f32_bf16 v18, v131, v17
  v_dot2c_f32_bf16 v19, v135, v17
  v_dot2c_f32_bf16 v20, v139, v17
  v_dot2c_f32_bf16 v21, v143, v17
  v_add_f32_dpp v22, v18, v18 row_ror:8 row_mask:0xf bank_mask:0xf
  v_add_f32_dpp v23, v19, v19 row_ror:8 row_mask:0xf bank_mask:0xf
  v_add_f32_dpp v22, v20, v20 row_ror:8 row_mask:0xf bank_mask:0xc
  v_add_f32_dpp v23, v21, v21 row_ror:8 row_mask:0xf bank_mask:0xc
  buffer_load_dwordx4 v[128:131], v9, s[24:27], s71 offen nt
  s_addk_i32 s71, 0x1000
  s_cmp_ge_u32 s71, s14
  s_cselect_b32 s71, 0, s71
  s_nop 0
  v_add_f32_dpp v27, v22, v22 row_ror:12 row_mask:0xf bank_mask:0x5
  v_add_f32_dpp v27, v23, v23 row_ror:4 row_mask:0xf bank_mask:0xa
  buffer_load_dwordx4 v[132:135], v9, s[24:27], s71 offen nt
  s_addk_i32 s71, 0x1000
  s_cmp_ge_u32 s71, s14
  s_cselect_b32 s71, 0, s71
  s_nop 0
  v_add_f32_dpp v27, v27, v27 quad_perm:[1,0,3,2] row_mask:0xf bank_mask:0xf
  buffer_load_dwordx4 v[136:139], v9, s[24:27], s71 offen nt
  s_addk_i32 s71, 0x1000
  s_cmp_ge_u32 s71, s14
  s_cselect_b32 s71, 0, s71
  s_nop 0
  v_add_f32_dpp v64, v27, v27 quad_perm:[2,3,0,1] row_mask:0xf bank_mask:0xf
  buffer_load_dwordx4 v[140:143], v9, s[24:27], s71 offen nt
  s_addk_i32 s71, 0x1000
  s_cmp_ge_u32 s71, s14
  s_cselect_b32 s71, 0, s71
  s_cmp_eq_u32 s15, 1
  s_cselect_b32 s78, 0xff800000, 0
  v_add_f32 v64, s78, v64
  v_max_f32 v24, v24, v64
  v_mov_b32 v100, 0
  v_mov_b32 v101, 0
  v_mov_b32 v102, 0
  v_mov_b32 v103, 0
  buffer_store_dwordx4 v[100:103], v55, s[52:55], 0 offen sc0 sc1
  s_mov_b32 s81, 0
  buffer_load_dword a128, v11, s[40:43], s81 offen offset:0 nt
  buffer_load_dword a129, v11, s[40:43], s81 offen offset:3584 nt
  s_addk_i32 s81, 7168
  buffer_load_dword a130, v11, s[40:43], s81 offen offset:0 nt
  buffer_load_dword a131, v11, s[40:43], s81 offen offset:3584 nt
  buffer_load_dwordx4 a[160:163], v12, s[44:47], 0 offen offset:0 nt
  v_dot2_f32_bf16 v18, v144, v14, 0
  v_dot2_f32_bf16 v19, v148, v14, 0
  v_dot2_f32_bf16 v20, v152, v14, 0
  v_dot2_f32_bf16 v21, v156, v14, 0
  v_dot2c_f32_bf16 v18, v145, v15
  v_dot2c_f32_bf16 v19, v149, v15
  v_dot2c_f32_bf16 v20, v153, v15
  v_dot2c_f32_bf16 v21, v157, v15
  v_dot2c_f32_bf16 v18, v146, v16
  v_dot2c_f32_bf16 v19, v150, v16
  v_dot2c_f32_bf16 v20, v154, v16
  v_dot2c_f32_bf16 v21, v158, v16
  v_dot2c_f32_bf16 v18, v147, v17
  v_dot2c_f32_bf16 v19, v151, v17
  v_dot2c_f32_bf16 v20, v155, v17
  v_dot2c_f32_bf16 v21, v159, v17
  v_add_f32_dpp v22, v18, v18 row_ror:8 row_mask:0xf bank_mask:0xf
  v_add_f32_dpp v23, v19, v19 row_ror:8 row_mask:0xf bank_mask:0xf
  v_add_f32_dpp v22, v20, v20 row_ror:8 row_mask:0xf bank_mask:0xc
  v_add_f32_dpp v23, v21, v21 row_ror:8 row_mask:0xf bank_mask:0xc
  buffer_load_dwordx4 v[144:147], v9, s[24:27], s71 offen nt
  s_addk_i32 s71, 0x1000
  s_cmp_ge_u32 s71, s14
  s_cselect_b32 s71, 0, s71
  s_nop 0
  v_add_f32_dpp v27, v22, v22 row_ror:12 row_mask:0xf bank_mask:0x5
  v_add_f32_dpp v27, v23, v23 row_ror:4 row_mask:0xf bank_mask:0xa
  buffer_load_dwordx4 v[148:151], v9, s[24:27], s71 offen nt
  s_addk_i32 s71, 0x1000
  s_cmp_ge_u32 s71, s14
  s_cselect_b32 s71, 0, s71
  s_nop 0
  v_add_f32_dpp v27, v27, v27 quad_perm:[1,0,3,2] row_mask:0xf bank_mask:0xf
  buffer_load_dwordx4 v[152:155], v9, s[24:27], s71 offen nt
  s_addk_i32 s71, 0x1000
  s_cmp_ge_u32 s71, s14
  s_cselect_b32 s71, 0, s71
  s_nop 0
  v_add_f32_dpp v65, v27, v27 quad_perm:[2,3,0,1] row_mask:0xf bank_mask:0xf
  buffer_load_dwordx4 v[156:159], v9, s[24:27], s71 offen nt
  s_addk_i32 s71, 0x1000
  s_cmp_ge_u32 s71, s14
  s_cselect_b32 s71, 0, s71
  s_cmp_eq_u32 s3, 1
  s_cselect_b32 s78, 0xff800000, 0
  v_add_f32 v65, s78, v65
  v_max_f32 v24, v24, v65
  s_mov_b32 s81, 14336
  buffer_load_dword a132, v11, s[40:43], s81 offen offset:0 nt
  buffer_load_dword a133, v11, s[40:43], s81 offen offset:3584 nt
  s_addk_i32 s81, 7168
  buffer_load_dword a134, v11, s[40:43], s81 offen offset:0 nt
  buffer_load_dword a135, v11, s[40:43], s81 offen offset:3584 nt
  buffer_load_dwordx4 a[164:167], v12, s[44:47], 0 offen offset:1024 nt
  v_dot2_f32_bf16 v18, v160, v14, 0
  v_dot2_f32_bf16 v19, v164, v14, 0
  v_dot2_f32_bf16 v20, v168, v14, 0
  v_dot2_f32_bf16 v21, v172, v14, 0
  v_dot2c_f32_bf16 v18, v161, v15
  v_dot2c_f32_bf16 v19, v165, v15
  v_dot2c_f32_bf16 v20, v169, v15
  v_dot2c_f32_bf16 v21, v173, v15
  v_dot2c_f32_bf16 v18, v162, v16
  v_dot2c_f32_bf16 v19, v166, v16
  v_dot2c_f32_bf16 v20, v170, v16
  v_dot2c_f32_bf16 v21, v174, v16
  v_dot2c_f32_bf16 v18, v163, v17
  v_dot2c_f32_bf16 v19, v167, v17
  v_dot2c_f32_bf16 v20, v171, v17
  v_dot2c_f32_bf16 v21, v175, v17
  v_add_f32_dpp v22, v18, v18 row_ror:8 row_mask:0xf bank_mask:0xf
  v_add_f32_dpp v23, v19, v19 row_ror:8 row_mask:0xf bank_mask:0xf
  v_add_f32_dpp v22, v20, v20 row_ror:8 row_mask:0xf bank_mask:0xc
  v_add_f32_dpp v23, v21, v21 row_ror:8 row_mask:0xf bank_mask:0xc
  buffer_load_dwordx4 v[160:163], v9, s[24:27], s71 offen nt
  s_addk_i32 s71, 0x1000
  s_cmp_ge_u32 s71, s14
  s_cselect_b32 s71, 0, s71
  s_nop 0
  v_add_f32_dpp v27, v22, v22 row_ror:12 row_mask:0xf bank_mask:0x5
  v_add_f32_dpp v27, v23, v23 row_ror:4 row_mask:0xf bank_mask:0xa
  buffer_load_dwordx4 v[164:167], v9, s[24:27], s71 offen nt
  s_addk_i32 s71, 0x1000
  s_cmp_ge_u32 s71, s14
  s_cselect_b32 s71, 0, s71
  s_nop 0
  v_add_f32_dpp v27, v27, v27 quad_perm:[1,0,3,2] row_mask:0xf bank_mask:0xf
  buffer_load_dwordx4 v[168:171], v9, s[24:27], s71 offen nt
  s_addk_i32 s71, 0x1000
  s_cmp_ge_u32 s71, s14
  s_cselect_b32 s71, 0, s71
  s_nop 0
  v_add_f32_dpp v66, v27, v27 quad_perm:[2,3,0,1] row_mask:0xf bank_mask:0xf
  buffer_load_dwordx4 v[172:175], v9, s[24:27], s71 offen nt
  s_addk_i32 s71, 0x1000
  s_cmp_ge_u32 s71, s14
  s_cselect_b32 s71, 0, s71
  v_max_f32 v24, v24, v66
  s_mov_b32 s81, 28672
  buffer_load_dword a136, v11, s[40:43], s81 offen offset:0 nt
  buffer_load_dword a137, v11, s[40:43], s81 offen offset:3584 nt
  s_addk_i32 s81, 7168
  buffer_load_dword a138, v11, s[40:43], s81 offen offset:0 nt
  buffer_load_dword a139, v11, s[40:43], s81 offen offset:3584 nt
  buffer_load_dwordx4 a[168:171], v12, s[44:47], 0 offen offset:2048 nt
  s_waitcnt vmcnt(60)
  v_dot2_f32_bf16 v18, v176, v14, 0
  v_dot2_f32_bf16 v19, v180, v14, 0
  v_dot2_f32_bf16 v20, v184, v14, 0
  v_dot2_f32_bf16 v21, v188, v14, 0
  v_dot2c_f32_bf16 v18, v177, v15
  v_dot2c_f32_bf16 v19, v181, v15
  v_dot2c_f32_bf16 v20, v185, v15
  v_dot2c_f32_bf16 v21, v189, v15
  v_dot2c_f32_bf16 v18, v178, v16
  v_dot2c_f32_bf16 v19, v182, v16
  v_dot2c_f32_bf16 v20, v186, v16
  v_dot2c_f32_bf16 v21, v190, v16
  v_dot2c_f32_bf16 v18, v179, v17
  v_dot2c_f32_bf16 v19, v183, v17
  v_dot2c_f32_bf16 v20, v187, v17
  v_dot2c_f32_bf16 v21, v191, v17
  v_add_f32_dpp v22, v18, v18 row_ror:8 row_mask:0xf bank_mask:0xf
  v_add_f32_dpp v23, v19, v19 row_ror:8 row_mask:0xf bank_mask:0xf
  v_add_f32_dpp v22, v20, v20 row_ror:8 row_mask:0xf bank_mask:0xc
  v_add_f32_dpp v23, v21, v21 row_ror:8 row_mask:0xf bank_mask:0xc
  buffer_load_dwordx4 v[176:179], v9, s[24:27], s71 offen nt
  s_addk_i32 s71, 0x1000
  s_cmp_ge_u32 s71, s14
  s_cselect_b32 s71, 0, s71
  s_nop 0
  v_add_f32_dpp v27, v22, v22 row_ror:12 row_mask:0xf bank_mask:0x5
  v_add_f32_dpp v27, v23, v23 row_ror:4 row_mask:0xf bank_mask:0xa
  buffer_load_dwordx4 v[180:183], v9, s[24:27], s71 offen nt
  s_addk_i32 s71, 0x1000
  s_cmp_ge_u32 s71, s14
  s_cselect_b32 s71, 0, s71
  s_nop 0
  v_add_f32_dpp v27, v27, v27 quad_perm:[1,0,3,2] row_mask:0xf bank_mask:0xf
  buffer_load_dwordx4 v[184:187], v9, s[24:27], s71 offen nt
  s_addk_i32 s71, 0x1000
  s_cmp_ge_u32 s71, s14
  s_cselect_b32 s71, 0, s71
  s_nop 0
  v_add_f32_dpp v67, v27, v27 quad_perm:[2,3,0,1] row_mask:0xf bank_mask:0xf
  buffer_load_dwordx4 v[188:191], v9, s[24:27], s71 offen nt
  s_addk_i32 s71, 0x1000
  s_cmp_ge_u32 s71, s14
  s_cselect_b32 s71, 0, s71
  v_max_f32 v24, v24, v67
  s_mov_b32 s81, 43008
  buffer_load_dword a140, v11, s[40:43], s81 offen offset:0 nt
  buffer_load_dword a141, v11, s[40:43], s81 offen offset:3584 nt
  s_addk_i32 s81, 7168
  buffer_load_dword a142, v11, s[40:43], s81 offen offset:0 nt
  buffer_load_dword a143, v11, s[40:43], s81 offen offset:3584 nt
  buffer_load_dwordx4 a[172:175], v12, s[44:47], 0 offen offset:3072 nt
  s_waitcnt vmcnt(63)
  v_dot2_f32_bf16 v18, v192, v14, 0
  v_dot2_f32_bf16 v19, v196, v14, 0
  v_dot2_f32_bf16 v20, v200, v14, 0
  v_dot2_f32_bf16 v21, v204, v14, 0
  v_dot2c_f32_bf16 v18, v193, v15
  v_dot2c_f32_bf16 v19, v197, v15
  v_dot2c_f32_bf16 v20, v201, v15
  v_dot2c_f32_bf16 v21, v205, v15
  v_dot2c_f32_bf16 v18, v194, v16
  v_dot2c_f32_bf16 v19, v198, v16
  v_dot2c_f32_bf16 v20, v202, v16
  v_dot2c_f32_bf16 v21, v206, v16
  v_dot2c_f32_bf16 v18, v195, v17
  v_dot2c_f32_bf16 v19, v199, v17
  v_dot2c_f32_bf16 v20, v203, v17
  v_dot2c_f32_bf16 v21, v207, v17
  v_add_f32_dpp v22, v18, v18 row_ror:8 row_mask:0xf bank_mask:0xf
  v_add_f32_dpp v23, v19, v19 row_ror:8 row_mask:0xf bank_mask:0xf
  v_add_f32_dpp v22, v20, v20 row_ror:8 row_mask:0xf bank_mask:0xc
  v_add_f32_dpp v23, v21, v21 row_ror:8 row_mask:0xf bank_mask:0xc
  buffer_load_dwordx4 v[192:195], v9, s[24:27], s71 offen nt
  s_addk_i32 s71, 0x1000
  s_cmp_ge_u32 s71, s14
  s_cselect_b32 s71, 0, s71
  s_nop 0
  v_add_f32_dpp v27, v22, v22 row_ror:12 row_mask:0xf bank_mask:0x5
  v_add_f32_dpp v27, v23, v23 row_ror:4 row_mask:0xf bank_mask:0xa
  buffer_load_dwordx4 v[196:199], v9, s[24:27], s71 offen nt
  s_addk_i32 s71, 0x1000
  s_cmp_ge_u32 s71, s14
  s_cselect_b32 s71, 0, s71
  s_nop 0
  v_add_f32_dpp v27, v27, v27 quad_perm:[1,0,3,2] row_mask:0xf bank_mask:0xf
  buffer_load_dwordx4 v[200:203], v9, s[24:27], s71 offen nt
  s_addk_i32 s71, 0x1000
  s_cmp_ge_u32 s71, s14
  s_cselect_b32 s71, 0, s71
  s_nop 0
  v_add_f32_dpp v68, v27, v27 quad_perm:[2,3,0,1] row_mask:0xf bank_mask:0xf
  buffer_load_dwordx4 v[204:207], v9, s[24:27], s71 offen nt
  s_addk_i32 s71, 0x1000
  s_cmp_ge_u32 s71, s14
  s_cselect_b32 s71, 0, s71
  v_max_f32 v24, v24, v68
  s_mov_b32 s81, 57344
  buffer_load_dword a144, v11, s[40:43], s81 offen offset:0 nt
  buffer_load_dword a145, v11, s[40:43], s81 offen offset:3584 nt
  s_addk_i32 s81, 7168
  buffer_load_dword a146, v11, s[40:43], s81 offen offset:0 nt
  buffer_load_dword a147, v11, s[40:43], s81 offen offset:3584 nt
  s_mov_b32 s80, 4096
  buffer_load_dwordx4 a[176:179], v12, s[44:47], s80 offen offset:0 nt
  s_waitcnt vmcnt(63)
  v_dot2_f32_bf16 v18, v208, v14, 0
  v_dot2_f32_bf16 v19, v212, v14, 0
  v_dot2_f32_bf16 v20, v216, v14, 0
  v_dot2_f32_bf16 v21, v220, v14, 0
  v_dot2c_f32_bf16 v18, v209, v15
  v_dot2c_f32_bf16 v19, v213, v15
  v_dot2c_f32_bf16 v20, v217, v15
  v_dot2c_f32_bf16 v21, v221, v15
  v_dot2c_f32_bf16 v18, v210, v16
  v_dot2c_f32_bf16 v19, v214, v16
  v_dot2c_f32_bf16 v20, v218, v16
  v_dot2c_f32_bf16 v21, v222, v16
  v_dot2c_f32_bf16 v18, v211, v17
  v_dot2c_f32_bf16 v19, v215, v17
  v_dot2c_f32_bf16 v20, v219, v17
  v_dot2c_f32_bf16 v21, v223, v17
  v_add_f32_dpp v22, v18, v18 row_ror:8 row_mask:0xf bank_mask:0xf
  v_add_f32_dpp v23, v19, v19 row_ror:8 row_mask:0xf bank_mask:0xf
  v_add_f32_dpp v22, v20, v20 row_ror:8 row_mask:0xf bank_mask:0xc
  v_add_f32_dpp v23, v21, v21 row_ror:8 row_mask:0xf bank_mask:0xc
  buffer_load_dwordx4 v[208:211], v9, s[24:27], s71 offen nt
  s_addk_i32 s71, 0x1000
  s_cmp_ge_u32 s71, s14
  s_cselect_b32 s71, 0, s71
  s_nop 0
  v_add_f32_dpp v27, v22, v22 row_ror:12 row_mask:0xf bank_mask:0x5
  v_add_f32_dpp v27, v23, v23 row_ror:4 row_mask:0xf bank_mask:0xa
  buffer_load_dwordx4 v[212:215], v9, s[24:27], s71 offen nt
  s_addk_i32 s71, 0x1000
  s_cmp_ge_u32 s71, s14
  s_cselect_b32 s71, 0, s71
  s_nop 0
  v_add_f32_dpp v27, v27, v27 quad_perm:[1,0,3,2] row_mask:0xf bank_mask:0xf
  buffer_load_dwordx4 v[216:219], v9, s[24:27], s71 offen nt
  s_addk_i32 s71, 0x1000
  s_cmp_ge_u32 s71, s14
  s_cselect_b32 s71, 0, s71
  s_nop 0
  v_add_f32_dpp v69, v27, v27 quad_perm:[2,3,0,1] row_mask:0xf bank_mask:0xf
  buffer_load_dwordx4 v[220:223], v9, s[24:27], s71 offen nt
  s_addk_i32 s71, 0x1000
  s_cmp_ge_u32 s71, s14
  s_cselect_b32 s71, 0, s71
  v_max_f32 v24, v24, v69
  s_mov_b32 s81, 71680
  buffer_load_dword a148, v11, s[40:43], s81 offen offset:0 nt
  buffer_load_dword a149, v11, s[40:43], s81 offen offset:3584 nt
  s_addk_i32 s81, 7168
  buffer_load_dword a150, v11, s[40:43], s81 offen offset:0 nt
  buffer_load_dword a151, v11, s[40:43], s81 offen offset:3584 nt
  buffer_load_dwordx4 a[180:183], v12, s[44:47], s80 offen offset:1024 nt
  v_dot2_f32_bf16 v18, v224, v14, 0
  v_dot2_f32_bf16 v19, v228, v14, 0
  v_dot2_f32_bf16 v20, v232, v14, 0
  v_dot2_f32_bf16 v21, v236, v14, 0
  v_dot2c_f32_bf16 v18, v225, v15
  v_dot2c_f32_bf16 v19, v229, v15
  v_dot2c_f32_bf16 v20, v233, v15
  v_dot2c_f32_bf16 v21, v237, v15
  v_dot2c_f32_bf16 v18, v226, v16
  v_dot2c_f32_bf16 v19, v230, v16
  v_dot2c_f32_bf16 v20, v234, v16
  v_dot2c_f32_bf16 v21, v238, v16
  v_dot2c_f32_bf16 v18, v227, v17
  v_dot2c_f32_bf16 v19, v231, v17
  v_dot2c_f32_bf16 v20, v235, v17
  v_dot2c_f32_bf16 v21, v239, v17
  v_add_f32_dpp v22, v18, v18 row_ror:8 row_mask:0xf bank_mask:0xf
  v_add_f32_dpp v23, v19, v19 row_ror:8 row_mask:0xf bank_mask:0xf
  v_add_f32_dpp v22, v20, v20 row_ror:8 row_mask:0xf bank_mask:0xc
  v_add_f32_dpp v23, v21, v21 row_ror:8 row_mask:0xf bank_mask:0xc
  buffer_load_dwordx4 v[224:227], v9, s[24:27], s71 offen nt
  s_addk_i32 s71, 0x1000
  s_cmp_ge_u32 s71, s14
  s_cselect_b32 s71, 0, s71
  s_nop 0
  v_add_f32_dpp v27, v22, v22 row_ror:12 row_mask:0xf bank_mask:0x5
  v_add_f32_dpp v27, v23, v23 row_ror:4 row_mask:0xf bank_mask:0xa
  buffer_load_dwordx4 v[228:231], v9, s[24:27], s71 offen nt
  s_addk_i32 s71, 0x1000
  s_cmp_ge_u32 s71, s14
  s_cselect_b32 s71, 0, s71
  s_nop 0
  v_add_f32_dpp v27, v27, v27 quad_perm:[1,0,3,2] row_mask:0xf bank_mask:0xf
  buffer_load_dwordx4 v[232:235], v9, s[24:27], s71 offen nt
  s_addk_i32 s71, 0x1000
  s_cmp_ge_u32 s71, s14
  s_cselect_b32 s71, 0, s71
  s_nop 0
  v_add_f32_dpp v70, v27, v27 quad_perm:[2,3,0,1] row_mask:0xf bank_mask:0xf
  buffer_load_dwordx4 v[236:239], v9, s[24:27], s71 offen nt
  s_addk_i32 s71, 0x1000
  s_cmp_ge_u32 s71, s14
  s_cselect_b32 s71, 0, s71
  v_max_f32 v24, v24, v70
  s_mov_b32 s81, 86016
  buffer_load_dword a152, v11, s[40:43], s81 offen offset:0 nt
  buffer_load_dword a153, v11, s[40:43], s81 offen offset:3584 nt
  s_addk_i32 s81, 7168
  buffer_load_dword a154, v11, s[40:43], s81 offen offset:0 nt
  buffer_load_dword a155, v11, s[40:43], s81 offen offset:3584 nt
  buffer_load_dwordx4 a[184:187], v12, s[44:47], s80 offen offset:2048 nt
  s_waitcnt vmcnt(63)
  v_dot2_f32_bf16 v18, v240, v14, 0
  v_dot2_f32_bf16 v19, v244, v14, 0
  v_dot2_f32_bf16 v20, v248, v14, 0
  v_dot2_f32_bf16 v21, v252, v14, 0
  v_dot2c_f32_bf16 v18, v241, v15
  v_dot2c_f32_bf16 v19, v245, v15
  v_dot2c_f32_bf16 v20, v249, v15
  v_dot2c_f32_bf16 v21, v253, v15
  v_dot2c_f32_bf16 v18, v242, v16
  v_dot2c_f32_bf16 v19, v246, v16
  v_dot2c_f32_bf16 v20, v250, v16
  v_dot2c_f32_bf16 v21, v254, v16
  v_dot2c_f32_bf16 v18, v243, v17
  v_dot2c_f32_bf16 v19, v247, v17
  v_dot2c_f32_bf16 v20, v251, v17
  v_dot2c_f32_bf16 v21, v255, v17
  v_add_f32_dpp v22, v18, v18 row_ror:8 row_mask:0xf bank_mask:0xf
  v_add_f32_dpp v23, v19, v19 row_ror:8 row_mask:0xf bank_mask:0xf
  v_add_f32_dpp v22, v20, v20 row_ror:8 row_mask:0xf bank_mask:0xc
  v_add_f32_dpp v23, v21, v21 row_ror:8 row_mask:0xf bank_mask:0xc
  buffer_load_dwordx4 v[240:243], v9, s[24:27], s71 offen nt
  s_addk_i32 s71, 0x1000
  s_cmp_ge_u32 s71, s14
  s_cselect_b32 s71, 0, s71
  s_nop 0
  v_add_f32_dpp v27, v22, v22 row_ror:12 row_mask:0xf bank_mask:0x5
  v_add_f32_dpp v27, v23, v23 row_ror:4 row_mask:0xf bank_mask:0xa
  buffer_load_dwordx4 v[244:247], v9, s[24:27], s71 offen nt
  s_addk_i32 s71, 0x1000
  s_cmp_ge_u32 s71, s14
  s_cselect_b32 s71, 0, s71
  s_nop 0
  v_add_f32_dpp v27, v27, v27 quad_perm:[1,0,3,2] row_mask:0xf bank_mask:0xf
  buffer_load_dwordx4 v[248:251], v9, s[24:27], s71 offen nt
  s_addk_i32 s71, 0x1000
  s_cmp_ge_u32 s71, s14
  s_cselect_b32 s71, 0, s71
  s_nop 0
  v_add_f32_dpp v71, v27, v27 quad_perm:[2,3,0,1] row_mask:0xf bank_mask:0xf
  buffer_load_dwordx4 v[252:255], v9, s[24:27], s71 offen nt
  s_addk_i32 s71, 0x1000
  s_cmp_ge_u32 s71, s14
  s_cselect_b32 s71, 0, s71
  v_max_f32 v24, v24, v71
  s_mov_b32 s81, 100352
  buffer_load_dword a156, v11, s[40:43], s81 offen offset:0 nt
  buffer_load_dword a157, v11, s[40:43], s81 offen offset:3584 nt
  s_addk_i32 s81, 7168
  buffer_load_dword a158, v11, s[40:43], s81 offen offset:0 nt
  buffer_load_dword a159, v11, s[40:43], s81 offen offset:3584 nt
  buffer_load_dwordx4 a[188:191], v12, s[44:47], s80 offen offset:3072 nt
  s_waitcnt vmcnt(63)
  v_dot2_f32_bf16 v18, v128, v14, 0
  v_dot2_f32_bf16 v19, v132, v14, 0
  v_dot2_f32_bf16 v20, v136, v14, 0
  v_dot2_f32_bf16 v21, v140, v14, 0
  v_dot2c_f32_bf16 v18, v129, v15
  v_dot2c_f32_bf16 v19, v133, v15
  v_dot2c_f32_bf16 v20, v137, v15
  v_dot2c_f32_bf16 v21, v141, v15
  v_dot2c_f32_bf16 v18, v130, v16
  v_dot2c_f32_bf16 v19, v134, v16
  v_dot2c_f32_bf16 v20, v138, v16
  v_dot2c_f32_bf16 v21, v142, v16
  v_dot2c_f32_bf16 v18, v131, v17
  v_dot2c_f32_bf16 v19, v135, v17
  v_dot2c_f32_bf16 v20, v139, v17
  v_dot2c_f32_bf16 v21, v143, v17
  v_add_f32_dpp v22, v18, v18 row_ror:8 row_mask:0xf bank_mask:0xf
  v_add_f32_dpp v23, v19, v19 row_ror:8 row_mask:0xf bank_mask:0xf
  v_add_f32_dpp v22, v20, v20 row_ror:8 row_mask:0xf bank_mask:0xc
  v_add_f32_dpp v23, v21, v21 row_ror:8 row_mask:0xf bank_mask:0xc
  buffer_load_dwordx4 v[128:131], v9, s[24:27], s71 offen nt
  s_addk_i32 s71, 0x1000
  s_cmp_ge_u32 s71, s14
  s_cselect_b32 s71, 0, s71
  s_nop 0
  v_add_f32_dpp v27, v22, v22 row_ror:12 row_mask:0xf bank_mask:0x5
  v_add_f32_dpp v27, v23, v23 row_ror:4 row_mask:0xf bank_mask:0xa
  buffer_load_dwordx4 v[132:135], v9, s[24:27], s71 offen nt
  s_addk_i32 s71, 0x1000
  s_cmp_ge_u32 s71, s14
  s_cselect_b32 s71, 0, s71
  s_nop 0
  v_add_f32_dpp v27, v27, v27 quad_perm:[1,0,3,2] row_mask:0xf bank_mask:0xf
  buffer_load_dwordx4 v[136:139], v9, s[24:27], s71 offen nt
  s_addk_i32 s71, 0x1000
  s_cmp_ge_u32 s71, s14
  s_cselect_b32 s71, 0, s71
  s_nop 0
  v_add_f32_dpp v72, v27, v27 quad_perm:[2,3,0,1] row_mask:0xf bank_mask:0xf
  buffer_load_dwordx4 v[140:143], v9, s[24:27], s71 offen nt
  s_addk_i32 s71, 0x1000
  s_cmp_ge_u32 s71, s14
  s_cselect_b32 s71, 0, s71
  v_max_f32 v24, v24, v72
  buffer_load_dwordx4 a[0:3], v13, s[36:39], 0 offen offset:0 nt
  buffer_load_dwordx4 a[4:7], v13, s[36:39], 0 offen offset:1024 nt
  s_waitcnt vmcnt(63)
  v_dot2_f32_bf16 v18, v144, v14, 0
  v_dot2_f32_bf16 v19, v148, v14, 0
  v_dot2_f32_bf16 v20, v152, v14, 0
  v_dot2_f32_bf16 v21, v156, v14, 0
  v_dot2c_f32_bf16 v18, v145, v15
  v_dot2c_f32_bf16 v19, v149, v15
  v_dot2c_f32_bf16 v20, v153, v15
  v_dot2c_f32_bf16 v21, v157, v15
  v_dot2c_f32_bf16 v18, v146, v16
  v_dot2c_f32_bf16 v19, v150, v16
  v_dot2c_f32_bf16 v20, v154, v16
  v_dot2c_f32_bf16 v21, v158, v16
  v_dot2c_f32_bf16 v18, v147, v17
  v_dot2c_f32_bf16 v19, v151, v17
  v_dot2c_f32_bf16 v20, v155, v17
  v_dot2c_f32_bf16 v21, v159, v17
  v_add_f32_dpp v22, v18, v18 row_ror:8 row_mask:0xf bank_mask:0xf
  v_add_f32_dpp v23, v19, v19 row_ror:8 row_mask:0xf bank_mask:0xf
  v_add_f32_dpp v22, v20, v20 row_ror:8 row_mask:0xf bank_mask:0xc
  v_add_f32_dpp v23, v21, v21 row_ror:8 row_mask:0xf bank_mask:0xc
  buffer_load_dwordx4 v[144:147], v9, s[24:27], s71 offen nt
  s_addk_i32 s71, 0x1000
  s_cmp_ge_u32 s71, s14
  s_cselect_b32 s71, 0, s71
  s_nop 0
  v_add_f32_dpp v27, v22, v22 row_ror:12 row_mask:0xf bank_mask:0x5
  v_add_f32_dpp v27, v23, v23 row_ror:4 row_mask:0xf bank_mask:0xa
  buffer_load_dwordx4 v[148:151], v9, s[24:27], s71 offen nt
  s_addk_i32 s71, 0x1000
  s_cmp_ge_u32 s71, s14
  s_cselect_b32 s71, 0, s71
  s_nop 0
  v_add_f32_dpp v27, v27, v27 quad_perm:[1,0,3,2] row_mask:0xf bank_mask:0xf
  buffer_load_dwordx4 v[152:155], v9, s[24:27], s71 offen nt
  s_addk_i32 s71, 0x1000
  s_cmp_ge_u32 s71, s14
  s_cselect_b32 s71, 0, s71
  s_nop 0
  v_add_f32_dpp v73, v27, v27 quad_perm:[2,3,0,1] row_mask:0xf bank_mask:0xf
  buffer_load_dwordx4 v[156:159], v9, s[24:27], s71 offen nt
  s_addk_i32 s71, 0x1000
  s_cmp_ge_u32 s71, s14
  s_cselect_b32 s71, 0, s71
  v_max_f32 v24, v24, v73
  buffer_load_dwordx4 a[8:11], v13, s[36:39], 0 offen offset:2048 nt
  buffer_load_dwordx4 a[12:15], v13, s[36:39], 0 offen offset:3072 nt
  s_waitcnt vmcnt(62)
  v_dot2_f32_bf16 v18, v160, v14, 0
  v_dot2_f32_bf16 v19, v164, v14, 0
  v_dot2_f32_bf16 v20, v168, v14, 0
  v_dot2_f32_bf16 v21, v172, v14, 0
  v_dot2c_f32_bf16 v18, v161, v15
  v_dot2c_f32_bf16 v19, v165, v15
  v_dot2c_f32_bf16 v20, v169, v15
  v_dot2c_f32_bf16 v21, v173, v15
  v_dot2c_f32_bf16 v18, v162, v16
  v_dot2c_f32_bf16 v19, v166, v16
  v_dot2c_f32_bf16 v20, v170, v16
  v_dot2c_f32_bf16 v21, v174, v16
  v_dot2c_f32_bf16 v18, v163, v17
  v_dot2c_f32_bf16 v19, v167, v17
  v_dot2c_f32_bf16 v20, v171, v17
  v_dot2c_f32_bf16 v21, v175, v17
  v_add_f32_dpp v22, v18, v18 row_ror:8 row_mask:0xf bank_mask:0xf
  v_add_f32_dpp v23, v19, v19 row_ror:8 row_mask:0xf bank_mask:0xf
  v_add_f32_dpp v22, v20, v20 row_ror:8 row_mask:0xf bank_mask:0xc
  v_add_f32_dpp v23, v21, v21 row_ror:8 row_mask:0xf bank_mask:0xc
  buffer_load_dwordx4 v[160:163], v9, s[24:27], s71 offen nt
  s_addk_i32 s71, 0x1000
  s_cmp_ge_u32 s71, s14
  s_cselect_b32 s71, 0, s71
  s_nop 0
  v_add_f32_dpp v27, v22, v22 row_ror:12 row_mask:0xf bank_mask:0x5
  v_add_f32_dpp v27, v23, v23 row_ror:4 row_mask:0xf bank_mask:0xa
  buffer_load_dwordx4 v[164:167], v9, s[24:27], s71 offen nt
  s_addk_i32 s71, 0x1000
  s_cmp_ge_u32 s71, s14
  s_cselect_b32 s71, 0, s71
  s_nop 0
  v_add_f32_dpp v27, v27, v27 quad_perm:[1,0,3,2] row_mask:0xf bank_mask:0xf
  buffer_load_dwordx4 v[168:171], v9, s[24:27], s71 offen nt
  s_addk_i32 s71, 0x1000
  s_cmp_ge_u32 s71, s14
  s_cselect_b32 s71, 0, s71
  s_nop 0
  v_add_f32_dpp v74, v27, v27 quad_perm:[2,3,0,1] row_mask:0xf bank_mask:0xf
  buffer_load_dwordx4 v[172:175], v9, s[24:27], s71 offen nt
  s_addk_i32 s71, 0x1000
  s_cmp_ge_u32 s71, s14
  s_cselect_b32 s71, 0, s71
  v_max_f32 v24, v24, v74
  s_mov_b64 exec, 1
  buffer_atomic_add v54, v53, s[56:59], 0 offen
  s_mov_b64 exec, -1
  s_mov_b32 s73, 4096
  buffer_load_dwordx4 a[16:19], v13, s[36:39], s73 offen offset:0 nt
  buffer_load_dwordx4 a[20:23], v13, s[36:39], s73 offen offset:1024 nt
  s_waitcnt vmcnt(60)
  v_dot2_f32_bf16 v18, v176, v14, 0
  v_dot2_f32_bf16 v19, v180, v14, 0
  v_dot2_f32_bf16 v20, v184, v14, 0
  v_dot2_f32_bf16 v21, v188, v14, 0
  v_dot2c_f32_bf16 v18, v177, v15
  v_dot2c_f32_bf16 v19, v181, v15
  v_dot2c_f32_bf16 v20, v185, v15
  v_dot2c_f32_bf16 v21, v189, v15
  v_dot2c_f32_bf16 v18, v178, v16
  v_dot2c_f32_bf16 v19, v182, v16
  v_dot2c_f32_bf16 v20, v186, v16
  v_dot2c_f32_bf16 v21, v190, v16
  v_dot2c_f32_bf16 v18, v179, v17
  v_dot2c_f32_bf16 v19, v183, v17
  v_dot2c_f32_bf16 v20, v187, v17
  v_dot2c_f32_bf16 v21, v191, v17
  v_add_f32_dpp v22, v18, v18 row_ror:8 row_mask:0xf bank_mask:0xf
  v_add_f32_dpp v23, v19, v19 row_ror:8 row_mask:0xf bank_mask:0xf
  v_add_f32_dpp v22, v20, v20 row_ror:8 row_mask:0xf bank_mask:0xc
  v_add_f32_dpp v23, v21, v21 row_ror:8 row_mask:0xf bank_mask:0xc
  buffer_load_dwordx4 v[176:179], v9, s[24:27], s71 offen nt
  s_addk_i32 s71, 0x1000
  s_cmp_ge_u32 s71, s14
  s_cselect_b32 s71, 0, s71
  s_nop 0
  v_add_f32_dpp v27, v22, v22 row_ror:12 row_mask:0xf bank_mask:0x5
  v_add_f32_dpp v27, v23, v23 row_ror:4 row_mask:0xf bank_mask:0xa
  buffer_load_dwordx4 v[180:183], v9, s[24:27], s71 offen nt
  s_addk_i32 s71, 0x1000
  s_cmp_ge_u32 s71, s14
  s_cselect_b32 s71, 0, s71
  s_nop 0
  v_add_f32_dpp v27, v27, v27 quad_perm:[1,0,3,2] row_mask:0xf bank_mask:0xf
  buffer_load_dwordx4 v[184:187], v9, s[24:27], s71 offen nt
  s_addk_i32 s71, 0x1000
  s_cmp_ge_u32 s71, s14
  s_cselect_b32 s71, 0, s71
  s_nop 0
  v_add_f32_dpp v75, v27, v27 quad_perm:[2,3,0,1] row_mask:0xf bank_mask:0xf
  buffer_load_dwordx4 v[188:191], v9, s[24:27], s71 offen nt
  s_addk_i32 s71, 0x1000
  s_cmp_ge_u32 s71, s14
  s_cselect_b32 s71, 0, s71
  v_max_f32 v24, v24, v75
  buffer_load_dwordx4 a[24:27], v13, s[36:39], s73 offen offset:2048 nt
  buffer_load_dwordx4 a[28:31], v13, s[36:39], s73 offen offset:3072 nt
  s_waitcnt vmcnt(57)
  v_dot2_f32_bf16 v18, v192, v14, 0
  v_dot2_f32_bf16 v19, v196, v14, 0
  v_dot2_f32_bf16 v20, v200, v14, 0
  v_dot2_f32_bf16 v21, v204, v14, 0
  v_dot2c_f32_bf16 v18, v193, v15
  v_dot2c_f32_bf16 v19, v197, v15
  v_dot2c_f32_bf16 v20, v201, v15
  v_dot2c_f32_bf16 v21, v205, v15
  v_dot2c_f32_bf16 v18, v194, v16
  v_dot2c_f32_bf16 v19, v198, v16
  v_dot2c_f32_bf16 v20, v202, v16
  v_dot2c_f32_bf16 v21, v206, v16
  v_dot2c_f32_bf16 v18, v195, v17
  v_dot2c_f32_bf16 v19, v199, v17
  v_dot2c_f32_bf16 v20, v203, v17
  v_dot2c_f32_bf16 v21, v207, v17
  v_add_f32_dpp v22, v18, v18 row_ror:8 row_mask:0xf bank_mask:0xf
  v_add_f32_dpp v23, v19, v19 row_ror:8 row_mask:0xf bank_mask:0xf
  v_add_f32_dpp v22, v20, v20 row_ror:8 row_mask:0xf bank_mask:0xc
  v_add_f32_dpp v23, v21, v21 row_ror:8 row_mask:0xf bank_mask:0xc
  buffer_load_dwordx4 v[192:195], v9, s[24:27], s71 offen nt
  s_addk_i32 s71, 0x1000
  s_cmp_ge_u32 s71, s14
  s_cselect_b32 s71, 0, s71
  s_nop 0
  v_add_f32_dpp v27, v22, v22 row_ror:12 row_mask:0xf bank_mask:0x5
  v_add_f32_dpp v27, v23, v23 row_ror:4 row_mask:0xf bank_mask:0xa
  buffer_load_dwordx4 v[196:199], v9, s[24:27], s71 offen nt
  s_addk_i32 s71, 0x1000
  s_cmp_ge_u32 s71, s14
  s_cselect_b32 s71, 0, s71
  s_nop 0
  v_add_f32_dpp v27, v27, v27 quad_perm:[1,0,3,2] row_mask:0xf bank_mask:0xf
  buffer_load_dwordx4 v[200:203], v9, s[24:27], s71 offen nt
  s_addk_i32 s71, 0x1000
  s_cmp_ge_u32 s71, s14
  s_cselect_b32 s71, 0, s71
  s_nop 0
  v_add_f32_dpp v76, v27, v27 quad_perm:[2,3,0,1] row_mask:0xf bank_mask:0xf
  buffer_load_dwordx4 v[204:207], v9, s[24:27], s71 offen nt
  s_addk_i32 s71, 0x1000
  s_cmp_ge_u32 s71, s14
  s_cselect_b32 s71, 0, s71
  v_max_f32 v24, v24, v76
  s_mov_b32 s73, 8192
  buffer_load_dwordx4 a[32:35], v13, s[36:39], s73 offen offset:0 nt
  buffer_load_dwordx4 a[36:39], v13, s[36:39], s73 offen offset:1024 nt
  s_waitcnt vmcnt(54)
  v_dot2_f32_bf16 v18, v208, v14, 0
  v_dot2_f32_bf16 v19, v212, v14, 0
  v_dot2_f32_bf16 v20, v216, v14, 0
  v_dot2_f32_bf16 v21, v220, v14, 0
  v_dot2c_f32_bf16 v18, v209, v15
  v_dot2c_f32_bf16 v19, v213, v15
  v_dot2c_f32_bf16 v20, v217, v15
  v_dot2c_f32_bf16 v21, v221, v15
  v_dot2c_f32_bf16 v18, v210, v16
  v_dot2c_f32_bf16 v19, v214, v16
  v_dot2c_f32_bf16 v20, v218, v16
  v_dot2c_f32_bf16 v21, v222, v16
  v_dot2c_f32_bf16 v18, v211, v17
  v_dot2c_f32_bf16 v19, v215, v17
  v_dot2c_f32_bf16 v20, v219, v17
  v_dot2c_f32_bf16 v21, v223, v17
  v_add_f32_dpp v22, v18, v18 row_ror:8 row_mask:0xf bank_mask:0xf
  v_add_f32_dpp v23, v19, v19 row_ror:8 row_mask:0xf bank_mask:0xf
  v_add_f32_dpp v22, v20, v20 row_ror:8 row_mask:0xf bank_mask:0xc
  v_add_f32_dpp v23, v21, v21 row_ror:8 row_mask:0xf bank_mask:0xc
  buffer_load_dwordx4 v[208:211], v9, s[24:27], s71 offen nt
  s_addk_i32 s71, 0x1000
  s_cmp_ge_u32 s71, s14
  s_cselect_b32 s71, 0, s71
  s_nop 0
  v_add_f32_dpp v27, v22, v22 row_ror:12 row_mask:0xf bank_mask:0x5
  v_add_f32_dpp v27, v23, v23 row_ror:4 row_mask:0xf bank_mask:0xa
  buffer_load_dwordx4 v[212:215], v9, s[24:27], s71 offen nt
  s_addk_i32 s71, 0x1000
  s_cmp_ge_u32 s71, s14
  s_cselect_b32 s71, 0, s71
  s_nop 0
  v_add_f32_dpp v27, v27, v27 quad_perm:[1,0,3,2] row_mask:0xf bank_mask:0xf
  buffer_load_dwordx4 v[216:219], v9, s[24:27], s71 offen nt
  s_addk_i32 s71, 0x1000
  s_cmp_ge_u32 s71, s14
  s_cselect_b32 s71, 0, s71
  s_nop 0
  v_add_f32_dpp v77, v27, v27 quad_perm:[2,3,0,1] row_mask:0xf bank_mask:0xf
  buffer_load_dwordx4 v[220:223], v9, s[24:27], s71 offen nt
  s_addk_i32 s71, 0x1000
  s_cmp_ge_u32 s71, s14
  s_cselect_b32 s71, 0, s71
  v_max_f32 v24, v24, v77
  buffer_load_dwordx4 a[40:43], v13, s[36:39], s73 offen offset:2048 nt
  buffer_load_dwordx4 a[44:47], v13, s[36:39], s73 offen offset:3072 nt
  s_waitcnt vmcnt(51)
  v_dot2_f32_bf16 v18, v224, v14, 0
  v_dot2_f32_bf16 v19, v228, v14, 0
  v_dot2_f32_bf16 v20, v232, v14, 0
  v_dot2_f32_bf16 v21, v236, v14, 0
  v_dot2c_f32_bf16 v18, v225, v15
  v_dot2c_f32_bf16 v19, v229, v15
  v_dot2c_f32_bf16 v20, v233, v15
  v_dot2c_f32_bf16 v21, v237, v15
  v_dot2c_f32_bf16 v18, v226, v16
  v_dot2c_f32_bf16 v19, v230, v16
  v_dot2c_f32_bf16 v20, v234, v16
  v_dot2c_f32_bf16 v21, v238, v16
  v_dot2c_f32_bf16 v18, v227, v17
  v_dot2c_f32_bf16 v19, v231, v17
  v_dot2c_f32_bf16 v20, v235, v17
  v_dot2c_f32_bf16 v21, v239, v17
  v_add_f32_dpp v22, v18, v18 row_ror:8 row_mask:0xf bank_mask:0xf
  v_add_f32_dpp v23, v19, v19 row_ror:8 row_mask:0xf bank_mask:0xf
  v_add_f32_dpp v22, v20, v20 row_ror:8 row_mask:0xf bank_mask:0xc
  v_add_f32_dpp v23, v21, v21 row_ror:8 row_mask:0xf bank_mask:0xc
  buffer_load_dwordx4 v[224:227], v9, s[24:27], s71 offen nt
  s_addk_i32 s71, 0x1000
  s_cmp_ge_u32 s71, s14
  s_cselect_b32 s71, 0, s71
  s_nop 0
  v_add_f32_dpp v27, v22, v22 row_ror:12 row_mask:0xf bank_mask:0x5
  v_add_f32_dpp v27, v23, v23 row_ror:4 row_mask:0xf bank_mask:0xa
  buffer_load_dwordx4 v[228:231], v9, s[24:27], s71 offen nt
  s_addk_i32 s71, 0x1000
  s_cmp_ge_u32 s71, s14
  s_cselect_b32 s71, 0, s71
  s_nop 0
  v_add_f32_dpp v27, v27, v27 quad_perm:[1,0,3,2] row_mask:0xf bank_mask:0xf
  buffer_load_dwordx4 v[232:235], v9, s[24:27], s71 offen nt
  s_addk_i32 s71, 0x1000
  s_cmp_ge_u32 s71, s14
  s_cselect_b32 s71, 0, s71
  s_nop 0
  v_add_f32_dpp v78, v27, v27 quad_perm:[2,3,0,1] row_mask:0xf bank_mask:0xf
  buffer_load_dwordx4 v[236:239], v9, s[24:27], s71 offen nt
  s_addk_i32 s71, 0x1000
  s_cmp_ge_u32 s71, s14
  s_cselect_b32 s71, 0, s71
  v_max_f32 v24, v24, v78
  s_mov_b32 s73, 12288
  buffer_load_dwordx4 a[48:51], v13, s[36:39], s73 offen offset:0 nt
  buffer_load_dwordx4 a[52:55], v13, s[36:39], s73 offen offset:1024 nt
  s_waitcnt vmcnt(48)
  v_dot2_f32_bf16 v18, v240, v14, 0
  v_dot2_f32_bf16 v19, v244, v14, 0
  v_dot2_f32_bf16 v20, v248, v14, 0
  v_dot2_f32_bf16 v21, v252, v14, 0
  v_dot2c_f32_bf16 v18, v241, v15
  v_dot2c_f32_bf16 v19, v245, v15
  v_dot2c_f32_bf16 v20, v249, v15
  v_dot2c_f32_bf16 v21, v253, v15
  v_dot2c_f32_bf16 v18, v242, v16
  v_dot2c_f32_bf16 v19, v246, v16
  v_dot2c_f32_bf16 v20, v250, v16
  v_dot2c_f32_bf16 v21, v254, v16
  v_dot2c_f32_bf16 v18, v243, v17
  v_dot2c_f32_bf16 v19, v247, v17
  v_dot2c_f32_bf16 v20, v251, v17
  v_dot2c_f32_bf16 v21, v255, v17
  v_add_f32_dpp v22, v18, v18 row_ror:8 row_mask:0xf bank_mask:0xf
  v_add_f32_dpp v23, v19, v19 row_ror:8 row_mask:0xf bank_mask:0xf
  v_add_f32_dpp v22, v20, v20 row_ror:8 row_mask:0xf bank_mask:0xc
  v_add_f32_dpp v23, v21, v21 row_ror:8 row_mask:0xf bank_mask:0xc
  buffer_load_dwordx4 v[240:243], v9, s[24:27], s71 offen nt
  s_addk_i32 s71, 0x1000
  s_cmp_ge_u32 s71, s14
  s_cselect_b32 s71, 0, s71
  s_nop 0
  v_add_f32_dpp v27, v22, v22 row_ror:12 row_mask:0xf bank_mask:0x5
  v_add_f32_dpp v27, v23, v23 row_ror:4 row_mask:0xf bank_mask:0xa
  buffer_load_dwordx4 v[244:247], v9, s[24:27], s71 offen nt
  s_addk_i32 s71, 0x1000
  s_cmp_ge_u32 s71, s14
  s_cselect_b32 s71, 0, s71
  s_nop 0
  v_add_f32_dpp v27, v27, v27 quad_perm:[1,0,3,2] row_mask:0xf bank_mask:0xf
  buffer_load_dwordx4 v[248:251], v9, s[24:27], s71 offen nt
  s_addk_i32 s71, 0x1000
  s_cmp_ge_u32 s71, s14
  s_cselect_b32 s71, 0, s71
  s_nop 0
  v_add_f32_dpp v79, v27, v27 quad_perm:[2,3,0,1] row_mask:0xf bank_mask:0xf
  buffer_load_dwordx4 v[252:255], v9, s[24:27], s71 offen nt
  s_addk_i32 s71, 0x1000
  s_cmp_ge_u32 s71, s14
  s_cselect_b32 s71, 0, s71
  v_max_f32 v24, v24, v79
  buffer_load_dwordx4 a[56:59], v13, s[36:39], s73 offen offset:2048 nt
  buffer_load_dwordx4 a[60:63], v13, s[36:39], s73 offen offset:3072 nt
  s_waitcnt vmcnt(45)
  v_dot2_f32_bf16 v18, v128, v14, 0
  v_dot2_f32_bf16 v19, v132, v14, 0
  v_dot2_f32_bf16 v20, v136, v14, 0
  v_dot2_f32_bf16 v21, v140, v14, 0
  v_dot2c_f32_bf16 v18, v129, v15
  v_dot2c_f32_bf16 v19, v133, v15
  v_dot2c_f32_bf16 v20, v137, v15
  v_dot2c_f32_bf16 v21, v141, v15
  v_dot2c_f32_bf16 v18, v130, v16
  v_dot2c_f32_bf16 v19, v134, v16
  v_dot2c_f32_bf16 v20, v138, v16
  v_dot2c_f32_bf16 v21, v142, v16
  v_dot2c_f32_bf16 v18, v131, v17
  v_dot2c_f32_bf16 v19, v135, v17
  v_dot2c_f32_bf16 v20, v139, v17
  v_dot2c_f32_bf16 v21, v143, v17
  v_add_f32_dpp v22, v18, v18 row_ror:8 row_mask:0xf bank_mask:0xf
  v_add_f32_dpp v23, v19, v19 row_ror:8 row_mask:0xf bank_mask:0xf
  v_add_f32_dpp v22, v20, v20 row_ror:8 row_mask:0xf bank_mask:0xc
  v_add_f32_dpp v23, v21, v21 row_ror:8 row_mask:0xf bank_mask:0xc
  buffer_load_dwordx4 v[128:131], v9, s[24:27], s71 offen nt
  s_addk_i32 s71, 0x1000
  s_cmp_ge_u32 s71, s14
  s_cselect_b32 s71, 0, s71
  s_nop 0
  v_add_f32_dpp v27, v22, v22 row_ror:12 row_mask:0xf bank_mask:0x5
  v_add_f32_dpp v27, v23, v23 row_ror:4 row_mask:0xf bank_mask:0xa
  buffer_load_dwordx4 v[132:135], v9, s[24:27], s71 offen nt
  s_addk_i32 s71, 0x1000
  s_cmp_ge_u32 s71, s14
  s_cselect_b32 s71, 0, s71
  s_nop 0
  v_add_f32_dpp v27, v27, v27 quad_perm:[1,0,3,2] row_mask:0xf bank_mask:0xf
  buffer_load_dwordx4 v[136:139], v9, s[24:27], s71 offen nt
  s_addk_i32 s71, 0x1000
  s_cmp_ge_u32 s71, s14
  s_cselect_b32 s71, 0, s71
  s_nop 0
  v_add_f32_dpp v80, v27, v27 quad_perm:[2,3,0,1] row_mask:0xf bank_mask:0xf
  buffer_load_dwordx4 v[140:143], v9, s[24:27], s71 offen nt
  s_addk_i32 s71, 0x1000
  s_cmp_ge_u32 s71, s14
  s_cselect_b32 s71, 0, s71
  v_max_f32 v24, v24, v80
  s_mov_b32 s73, 16384
  buffer_load_dwordx4 a[64:67], v13, s[36:39], s73 offen offset:0 nt
  buffer_load_dwordx4 a[68:71], v13, s[36:39], s73 offen offset:1024 nt
  s_waitcnt vmcnt(45)
  v_dot2_f32_bf16 v18, v144, v14, 0
  v_dot2_f32_bf16 v19, v148, v14, 0
  v_dot2_f32_bf16 v20, v152, v14, 0
  v_dot2_f32_bf16 v21, v156, v14, 0
  v_dot2c_f32_bf16 v18, v145, v15
  v_dot2c_f32_bf16 v19, v149, v15
  v_dot2c_f32_bf16 v20, v153, v15
  v_dot2c_f32_bf16 v21, v157, v15
  v_dot2c_f32_bf16 v18, v146, v16
  v_dot2c_f32_bf16 v19, v150, v16
  v_dot2c_f32_bf16 v20, v154, v16
  v_dot2c_f32_bf16 v21, v158, v16
  v_dot2c_f32_bf16 v18, v147, v17
  v_dot2c_f32_bf16 v19, v151, v17
  v_dot2c_f32_bf16 v20, v155, v17
  v_dot2c_f32_bf16 v21, v159, v17
  v_add_f32_dpp v22, v18, v18 row_ror:8 row_mask:0xf bank_mask:0xf
  v_add_f32_dpp v23, v19, v19 row_ror:8 row_mask:0xf bank_mask:0xf
  v_add_f32_dpp v22, v20, v20 row_ror:8 row_mask:0xf bank_mask:0xc
  v_add_f32_dpp v23, v21, v21 row_ror:8 row_mask:0xf bank_mask:0xc
  buffer_load_dwordx4 v[144:147], v9, s[24:27], s71 offen nt
  s_addk_i32 s71, 0x1000
  s_cmp_ge_u32 s71, s14
  s_cselect_b32 s71, 0, s71
  s_nop 0
  v_add_f32_dpp v27, v22, v22 row_ror:12 row_mask:0xf bank_mask:0x5
  v_add_f32_dpp v27, v23, v23 row_ror:4 row_mask:0xf bank_mask:0xa
  buffer_load_dwordx4 v[148:151], v9, s[24:27], s71 offen nt
  s_addk_i32 s71, 0x1000
  s_cmp_ge_u32 s71, s14
  s_cselect_b32 s71, 0, s71
  s_nop 0
  v_add_f32_dpp v27, v27, v27 quad_perm:[1,0,3,2] row_mask:0xf bank_mask:0xf
  buffer_load_dwordx4 v[152:155], v9, s[24:27], s71 offen nt
  s_addk_i32 s71, 0x1000
  s_cmp_ge_u32 s71, s14
  s_cselect_b32 s71, 0, s71
  s_nop 0
  v_add_f32_dpp v81, v27, v27 quad_perm:[2,3,0,1] row_mask:0xf bank_mask:0xf
  buffer_load_dwordx4 v[156:159], v9, s[24:27], s71 offen nt
  s_addk_i32 s71, 0x1000
  s_cmp_ge_u32 s71, s14
  s_cselect_b32 s71, 0, s71
  v_max_f32 v24, v24, v81
  buffer_load_dwordx4 a[72:75], v13, s[36:39], s73 offen offset:2048 nt
  buffer_load_dwordx4 a[76:79], v13, s[36:39], s73 offen offset:3072 nt
  s_waitcnt vmcnt(45)
  v_dot2_f32_bf16 v18, v160, v14, 0
  v_dot2_f32_bf16 v19, v164, v14, 0
  v_dot2_f32_bf16 v20, v168, v14, 0
  v_dot2_f32_bf16 v21, v172, v14, 0
  v_dot2c_f32_bf16 v18, v161, v15
  v_dot2c_f32_bf16 v19, v165, v15
  v_dot2c_f32_bf16 v20, v169, v15
  v_dot2c_f32_bf16 v21, v173, v15
  v_dot2c_f32_bf16 v18, v162, v16
  v_dot2c_f32_bf16 v19, v166, v16
  v_dot2c_f32_bf16 v20, v170, v16
  v_dot2c_f32_bf16 v21, v174, v16
  v_dot2c_f32_bf16 v18, v163, v17
  v_dot2c_f32_bf16 v19, v167, v17
  v_dot2c_f32_bf16 v20, v171, v17
  v_dot2c_f32_bf16 v21, v175, v17
  v_add_f32_dpp v22, v18, v18 row_ror:8 row_mask:0xf bank_mask:0xf
  v_add_f32_dpp v23, v19, v19 row_ror:8 row_mask:0xf bank_mask:0xf
  v_add_f32_dpp v22, v20, v20 row_ror:8 row_mask:0xf bank_mask:0xc
  v_add_f32_dpp v23, v21, v21 row_ror:8 row_mask:0xf bank_mask:0xc
  buffer_load_dwordx4 v[160:163], v9, s[24:27], s71 offen nt
  s_addk_i32 s71, 0x1000
  s_cmp_ge_u32 s71, s14
  s_cselect_b32 s71, 0, s71
  s_nop 0
  v_add_f32_dpp v27, v22, v22 row_ror:12 row_mask:0xf bank_mask:0x5
  v_add_f32_dpp v27, v23, v23 row_ror:4 row_mask:0xf bank_mask:0xa
  buffer_load_dwordx4 v[164:167], v9, s[24:27], s71 offen nt
  s_addk_i32 s71, 0x1000
  s_cmp_ge_u32 s71, s14
  s_cselect_b32 s71, 0, s71
  s_nop 0
  v_add_f32_dpp v27, v27, v27 quad_perm:[1,0,3,2] row_mask:0xf bank_mask:0xf
  buffer_load_dwordx4 v[168:171], v9, s[24:27], s71 offen nt
  s_addk_i32 s71, 0x1000
  s_cmp_ge_u32 s71, s14
  s_cselect_b32 s71, 0, s71
  s_nop 0
  v_add_f32_dpp v82, v27, v27 quad_perm:[2,3,0,1] row_mask:0xf bank_mask:0xf
  buffer_load_dwordx4 v[172:175], v9, s[24:27], s71 offen nt
  s_addk_i32 s71, 0x1000
  s_cmp_ge_u32 s71, s14
  s_cselect_b32 s71, 0, s71
  v_max_f32 v24, v24, v82
  s_mov_b32 s73, 20480
  buffer_load_dwordx4 a[80:83], v13, s[36:39], s73 offen offset:0 nt
  buffer_load_dwordx4 a[84:87], v13, s[36:39], s73 offen offset:1024 nt
  s_waitcnt vmcnt(44)
  v_dot2_f32_bf16 v18, v176, v14, 0
  v_dot2_f32_bf16 v19, v180, v14, 0
  v_dot2_f32_bf16 v20, v184, v14, 0
  v_dot2_f32_bf16 v21, v188, v14, 0
  v_dot2c_f32_bf16 v18, v177, v15
  v_dot2c_f32_bf16 v19, v181, v15
  v_dot2c_f32_bf16 v20, v185, v15
  v_dot2c_f32_bf16 v21, v189, v15
  v_dot2c_f32_bf16 v18, v178, v16
  v_dot2c_f32_bf16 v19, v182, v16
  v_dot2c_f32_bf16 v20, v186, v16
  v_dot2c_f32_bf16 v21, v190, v16
  v_dot2c_f32_bf16 v18, v179, v17
  v_dot2c_f32_bf16 v19, v183, v17
  v_dot2c_f32_bf16 v20, v187, v17
  v_dot2c_f32_bf16 v21, v191, v17
  v_add_f32_dpp v22, v18, v18 row_ror:8 row_mask:0xf bank_mask:0xf
  v_add_f32_dpp v23, v19, v19 row_ror:8 row_mask:0xf bank_mask:0xf
  v_add_f32_dpp v22, v20, v20 row_ror:8 row_mask:0xf bank_mask:0xc
  v_add_f32_dpp v23, v21, v21 row_ror:8 row_mask:0xf bank_mask:0xc
  buffer_load_dwordx4 v[176:179], v9, s[24:27], s71 offen nt
  s_addk_i32 s71, 0x1000
  s_cmp_ge_u32 s71, s14
  s_cselect_b32 s71, 0, s71
  s_nop 0
  v_add_f32_dpp v27, v22, v22 row_ror:12 row_mask:0xf bank_mask:0x5
  v_add_f32_dpp v27, v23, v23 row_ror:4 row_mask:0xf bank_mask:0xa
  buffer_load_dwordx4 v[180:183], v9, s[24:27], s71 offen nt
  s_addk_i32 s71, 0x1000
  s_cmp_ge_u32 s71, s14
  s_cselect_b32 s71, 0, s71
  s_nop 0
  v_add_f32_dpp v27, v27, v27 quad_perm:[1,0,3,2] row_mask:0xf bank_mask:0xf
  buffer_load_dwordx4 v[184:187], v9, s[24:27], s71 offen nt
  s_addk_i32 s71, 0x1000
  s_cmp_ge_u32 s71, s14
  s_cselect_b32 s71, 0, s71
  s_nop 0
  v_add_f32_dpp v83, v27, v27 quad_perm:[2,3,0,1] row_mask:0xf bank_mask:0xf
  buffer_load_dwordx4 v[188:191], v9, s[24:27], s71 offen nt
  s_addk_i32 s71, 0x1000
  s_cmp_ge_u32 s71, s14
  s_cselect_b32 s71, 0, s71
  v_max_f32 v24, v24, v83
  buffer_load_dwordx4 a[88:91], v13, s[36:39], s73 offen offset:2048 nt
  buffer_load_dwordx4 a[92:95], v13, s[36:39], s73 offen offset:3072 nt
  s_waitcnt vmcnt(44)
  v_dot2_f32_bf16 v18, v192, v14, 0
  v_dot2_f32_bf16 v19, v196, v14, 0
  v_dot2_f32_bf16 v20, v200, v14, 0
  v_dot2_f32_bf16 v21, v204, v14, 0
  v_dot2c_f32_bf16 v18, v193, v15
  v_dot2c_f32_bf16 v19, v197, v15
  v_dot2c_f32_bf16 v20, v201, v15
  v_dot2c_f32_bf16 v21, v205, v15
  v_dot2c_f32_bf16 v18, v194, v16
  v_dot2c_f32_bf16 v19, v198, v16
  v_dot2c_f32_bf16 v20, v202, v16
  v_dot2c_f32_bf16 v21, v206, v16
  v_dot2c_f32_bf16 v18, v195, v17
  v_dot2c_f32_bf16 v19, v199, v17
  v_dot2c_f32_bf16 v20, v203, v17
  v_dot2c_f32_bf16 v21, v207, v17
  v_add_f32_dpp v22, v18, v18 row_ror:8 row_mask:0xf bank_mask:0xf
  v_add_f32_dpp v23, v19, v19 row_ror:8 row_mask:0xf bank_mask:0xf
  v_add_f32_dpp v22, v20, v20 row_ror:8 row_mask:0xf bank_mask:0xc
  v_add_f32_dpp v23, v21, v21 row_ror:8 row_mask:0xf bank_mask:0xc
  buffer_load_dwordx4 v[192:195], v9, s[24:27], s71 offen nt
  s_addk_i32 s71, 0x1000
  s_cmp_ge_u32 s71, s14
  s_cselect_b32 s71, 0, s71
  s_nop 0
  v_add_f32_dpp v27, v22, v22 row_ror:12 row_mask:0xf bank_mask:0x5
  v_add_f32_dpp v27, v23, v23 row_ror:4 row_mask:0xf bank_mask:0xa
  buffer_load_dwordx4 v[196:199], v9, s[24:27], s71 offen nt
  s_addk_i32 s71, 0x1000
  s_cmp_ge_u32 s71, s14
  s_cselect_b32 s71, 0, s71
  s_nop 0
  v_add_f32_dpp v27, v27, v27 quad_perm:[1,0,3,2] row_mask:0xf bank_mask:0xf
  buffer_load_dwordx4 v[200:203], v9, s[24:27], s71 offen nt
  s_addk_i32 s71, 0x1000
  s_cmp_ge_u32 s71, s14
  s_cselect_b32 s71, 0, s71
  s_nop 0
  v_add_f32_dpp v84, v27, v27 quad_perm:[2,3,0,1] row_mask:0xf bank_mask:0xf
  buffer_load_dwordx4 v[204:207], v9, s[24:27], s71 offen nt
  s_addk_i32 s71, 0x1000
  s_cmp_ge_u32 s71, s14
  s_cselect_b32 s71, 0, s71
  v_max_f32 v24, v24, v84
  s_mov_b32 s73, 24576
  buffer_load_dwordx4 a[96:99], v13, s[36:39], s73 offen offset:0 nt
  buffer_load_dwordx4 a[100:103], v13, s[36:39], s73 offen offset:1024 nt
  s_waitcnt vmcnt(44)
  v_dot2_f32_bf16 v18, v208, v14, 0
  v_dot2_f32_bf16 v19, v212, v14, 0
  v_dot2_f32_bf16 v20, v216, v14, 0
  v_dot2_f32_bf16 v21, v220, v14, 0
  v_dot2c_f32_bf16 v18, v209, v15
  v_dot2c_f32_bf16 v19, v213, v15
  v_dot2c_f32_bf16 v20, v217, v15
  v_dot2c_f32_bf16 v21, v221, v15
  v_dot2c_f32_bf16 v18, v210, v16
  v_dot2c_f32_bf16 v19, v214, v16
  v_dot2c_f32_bf16 v20, v218, v16
  v_dot2c_f32_bf16 v21, v222, v16
  v_dot2c_f32_bf16 v18, v211, v17
  v_dot2c_f32_bf16 v19, v215, v17
  v_dot2c_f32_bf16 v20, v219, v17
  v_dot2c_f32_bf16 v21, v223, v17
  v_add_f32_dpp v22, v18, v18 row_ror:8 row_mask:0xf bank_mask:0xf
  v_add_f32_dpp v23, v19, v19 row_ror:8 row_mask:0xf bank_mask:0xf
  v_add_f32_dpp v22, v20, v20 row_ror:8 row_mask:0xf bank_mask:0xc
  v_add_f32_dpp v23, v21, v21 row_ror:8 row_mask:0xf bank_mask:0xc
  buffer_load_dwordx4 v[208:211], v9, s[24:27], s71 offen nt
  s_addk_i32 s71, 0x1000
  s_cmp_ge_u32 s71, s14
  s_cselect_b32 s71, 0, s71
  s_nop 0
  v_add_f32_dpp v27, v22, v22 row_ror:12 row_mask:0xf bank_mask:0x5
  v_add_f32_dpp v27, v23, v23 row_ror:4 row_mask:0xf bank_mask:0xa
  buffer_load_dwordx4 v[212:215], v9, s[24:27], s71 offen nt
  s_addk_i32 s71, 0x1000
  s_cmp_ge_u32 s71, s14
  s_cselect_b32 s71, 0, s71
  s_nop 0
  v_add_f32_dpp v27, v27, v27 quad_perm:[1,0,3,2] row_mask:0xf bank_mask:0xf
  buffer_load_dwordx4 v[216:219], v9, s[24:27], s71 offen nt
  s_addk_i32 s71, 0x1000
  s_cmp_ge_u32 s71, s14
  s_cselect_b32 s71, 0, s71
  s_nop 0
  v_add_f32_dpp v85, v27, v27 quad_perm:[2,3,0,1] row_mask:0xf bank_mask:0xf
  buffer_load_dwordx4 v[220:223], v9, s[24:27], s71 offen nt
  s_addk_i32 s71, 0x1000
  s_cmp_ge_u32 s71, s14
  s_cselect_b32 s71, 0, s71
  v_max_f32 v24, v24, v85
  buffer_load_dwordx4 a[104:107], v13, s[36:39], s73 offen offset:2048 nt
  buffer_load_dwordx4 a[108:111], v13, s[36:39], s73 offen offset:3072 nt
  s_waitcnt vmcnt(44)
  v_dot2_f32_bf16 v18, v224, v14, 0
  v_dot2_f32_bf16 v19, v228, v14, 0
  v_dot2_f32_bf16 v20, v232, v14, 0
  v_dot2_f32_bf16 v21, v236, v14, 0
  v_dot2c_f32_bf16 v18, v225, v15
  v_dot2c_f32_bf16 v19, v229, v15
  v_dot2c_f32_bf16 v20, v233, v15
  v_dot2c_f32_bf16 v21, v237, v15
  v_dot2c_f32_bf16 v18, v226, v16
  v_dot2c_f32_bf16 v19, v230, v16
  v_dot2c_f32_bf16 v20, v234, v16
  v_dot2c_f32_bf16 v21, v238, v16
  v_dot2c_f32_bf16 v18, v227, v17
  v_dot2c_f32_bf16 v19, v231, v17
  v_dot2c_f32_bf16 v20, v235, v17
  v_dot2c_f32_bf16 v21, v239, v17
  v_add_f32_dpp v22, v18, v18 row_ror:8 row_mask:0xf bank_mask:0xf
  v_add_f32_dpp v23, v19, v19 row_ror:8 row_mask:0xf bank_mask:0xf
  v_add_f32_dpp v22, v20, v20 row_ror:8 row_mask:0xf bank_mask:0xc
  v_add_f32_dpp v23, v21, v21 row_ror:8 row_mask:0xf bank_mask:0xc
  buffer_load_dwordx4 v[224:227], v9, s[24:27], s71 offen nt
  s_addk_i32 s71, 0x1000
  s_cmp_ge_u32 s71, s14
  s_cselect_b32 s71, 0, s71
  s_nop 0
  v_add_f32_dpp v27, v22, v22 row_ror:12 row_mask:0xf bank_mask:0x5
  v_add_f32_dpp v27, v23, v23 row_ror:4 row_mask:0xf bank_mask:0xa
  buffer_load_dwordx4 v[228:231], v9, s[24:27], s71 offen nt
  s_addk_i32 s71, 0x1000
  s_cmp_ge_u32 s71, s14
  s_cselect_b32 s71, 0, s71
  s_nop 0
  v_add_f32_dpp v27, v27, v27 quad_perm:[1,0,3,2] row_mask:0xf bank_mask:0xf
  buffer_load_dwordx4 v[232:235], v9, s[24:27], s71 offen nt
  s_addk_i32 s71, 0x1000
  s_cmp_ge_u32 s71, s14
  s_cselect_b32 s71, 0, s71
  s_nop 0
  v_add_f32_dpp v86, v27, v27 quad_perm:[2,3,0,1] row_mask:0xf bank_mask:0xf
  buffer_load_dwordx4 v[236:239], v9, s[24:27], s71 offen nt
  s_addk_i32 s71, 0x1000
  s_cmp_ge_u32 s71, s14
  s_cselect_b32 s71, 0, s71
  v_max_f32 v24, v24, v86
  s_mov_b32 s73, 28672
  buffer_load_dwordx4 a[112:115], v13, s[36:39], s73 offen offset:0 nt
  buffer_load_dwordx4 a[116:119], v13, s[36:39], s73 offen offset:1024 nt
  s_waitcnt vmcnt(44)
  v_dot2_f32_bf16 v18, v240, v14, 0
  v_dot2_f32_bf16 v19, v244, v14, 0
  v_dot2_f32_bf16 v20, v248, v14, 0
  v_dot2_f32_bf16 v21, v252, v14, 0
  v_dot2c_f32_bf16 v18, v241, v15
  v_dot2c_f32_bf16 v19, v245, v15
  v_dot2c_f32_bf16 v20, v249, v15
  v_dot2c_f32_bf16 v21, v253, v15
  v_dot2c_f32_bf16 v18, v242, v16
  v_dot2c_f32_bf16 v19, v246, v16
  v_dot2c_f32_bf16 v20, v250, v16
  v_dot2c_f32_bf16 v21, v254, v16
  v_dot2c_f32_bf16 v18, v243, v17
  v_dot2c_f32_bf16 v19, v247, v17
  v_dot2c_f32_bf16 v20, v251, v17
  v_dot2c_f32_bf16 v21, v255, v17
  v_add_f32_dpp v22, v18, v18 row_ror:8 row_mask:0xf bank_mask:0xf
  v_add_f32_dpp v23, v19, v19 row_ror:8 row_mask:0xf bank_mask:0xf
  v_add_f32_dpp v22, v20, v20 row_ror:8 row_mask:0xf bank_mask:0xc
  v_add_f32_dpp v23, v21, v21 row_ror:8 row_mask:0xf bank_mask:0xc
  buffer_load_dwordx4 v[240:243], v9, s[24:27], s71 offen nt
  s_addk_i32 s71, 0x1000
  s_cmp_ge_u32 s71, s14
  s_cselect_b32 s71, 0, s71
  s_nop 0
  v_add_f32_dpp v27, v22, v22 row_ror:12 row_mask:0xf bank_mask:0x5
  v_add_f32_dpp v27, v23, v23 row_ror:4 row_mask:0xf bank_mask:0xa
  buffer_load_dwordx4 v[244:247], v9, s[24:27], s71 offen nt
  s_addk_i32 s71, 0x1000
  s_cmp_ge_u32 s71, s14
  s_cselect_b32 s71, 0, s71
  s_nop 0
  v_add_f32_dpp v27, v27, v27 quad_perm:[1,0,3,2] row_mask:0xf bank_mask:0xf
  buffer_load_dwordx4 v[248:251], v9, s[24:27], s71 offen nt
  s_addk_i32 s71, 0x1000
  s_cmp_ge_u32 s71, s14
  s_cselect_b32 s71, 0, s71
  s_nop 0
  v_add_f32_dpp v87, v27, v27 quad_perm:[2,3,0,1] row_mask:0xf bank_mask:0xf
  buffer_load_dwordx4 v[252:255], v9, s[24:27], s71 offen nt
  s_addk_i32 s71, 0x1000
  s_cmp_ge_u32 s71, s14
  s_cselect_b32 s71, 0, s71
  v_max_f32 v24, v24, v87
  buffer_load_dwordx4 a[120:123], v13, s[36:39], s73 offen offset:2048 nt
  buffer_load_dwordx4 a[124:127], v13, s[36:39], s73 offen offset:3072 nt
  s_waitcnt vmcnt(44)
  v_dot2_f32_bf16 v18, v128, v14, 0
  v_dot2_f32_bf16 v19, v132, v14, 0
  v_dot2_f32_bf16 v20, v136, v14, 0
  v_dot2_f32_bf16 v21, v140, v14, 0
  v_dot2c_f32_bf16 v18, v129, v15
  v_dot2c_f32_bf16 v19, v133, v15
  v_dot2c_f32_bf16 v20, v137, v15
  v_dot2c_f32_bf16 v21, v141, v15
  v_dot2c_f32_bf16 v18, v130, v16
  v_dot2c_f32_bf16 v19, v134, v16
  v_dot2c_f32_bf16 v20, v138, v16
  v_dot2c_f32_bf16 v21, v142, v16
  v_dot2c_f32_bf16 v18, v131, v17
  v_dot2c_f32_bf16 v19, v135, v17
  v_dot2c_f32_bf16 v20, v139, v17
  v_dot2c_f32_bf16 v21, v143, v17
  v_add_f32_dpp v22, v18, v18 row_ror:8 row_mask:0xf bank_mask:0xf
  v_add_f32_dpp v23, v19, v19 row_ror:8 row_mask:0xf bank_mask:0xf
  v_add_f32_dpp v22, v20, v20 row_ror:8 row_mask:0xf bank_mask:0xc
  v_add_f32_dpp v23, v21, v21 row_ror:8 row_mask:0xf bank_mask:0xc
  buffer_load_dwordx4 v[128:131], v9, s[24:27], s71 offen nt
  s_addk_i32 s71, 0x1000
  s_cmp_ge_u32 s71, s14
  s_cselect_b32 s71, 0, s71
  s_nop 0
  v_add_f32_dpp v27, v22, v22 row_ror:12 row_mask:0xf bank_mask:0x5
  v_add_f32_dpp v27, v23, v23 row_ror:4 row_mask:0xf bank_mask:0xa
  buffer_load_dwordx4 v[132:135], v9, s[24:27], s71 offen nt
  s_addk_i32 s71, 0x1000
  s_cmp_ge_u32 s71, s14
  s_cselect_b32 s71, 0, s71
  s_nop 0
  v_add_f32_dpp v27, v27, v27 quad_perm:[1,0,3,2] row_mask:0xf bank_mask:0xf
  buffer_load_dwordx4 v[136:139], v9, s[24:27], s71 offen nt
  s_addk_i32 s71, 0x1000
  s_cmp_ge_u32 s71, s14
  s_cselect_b32 s71, 0, s71
  s_nop 0
  v_add_f32_dpp v88, v27, v27 quad_perm:[2,3,0,1] row_mask:0xf bank_mask:0xf
  buffer_load_dwordx4 v[140:143], v9, s[24:27], s71 offen nt
  s_addk_i32 s71, 0x1000
  s_cmp_ge_u32 s71, s14
  s_cselect_b32 s71, 0, s71
  v_max_f32 v24, v24, v88
  s_waitcnt vmcnt(42)
  v_dot2_f32_bf16 v18, v144, v14, 0
  v_dot2_f32_bf16 v19, v148, v14, 0
  v_dot2_f32_bf16 v20, v152, v14, 0
  v_dot2_f32_bf16 v21, v156, v14, 0
  v_dot2c_f32_bf16 v18, v145, v15
  v_dot2c_f32_bf16 v19, v149, v15
  v_dot2c_f32_bf16 v20, v153, v15
  v_dot2c_f32_bf16 v21, v157, v15
  v_dot2c_f32_bf16 v18, v146, v16
  v_dot2c_f32_bf16 v19, v150, v16
  v_dot2c_f32_bf16 v20, v154, v16
  v_dot2c_f32_bf16 v21, v158, v16
  v_dot2c_f32_bf16 v18, v147, v17
  v_dot2c_f32_bf16 v19, v151, v17
  v_dot2c_f32_bf16 v20, v155, v17
  v_dot2c_f32_bf16 v21, v159, v17
  v_add_f32_dpp v22, v18, v18 row_ror:8 row_mask:0xf bank_mask:0xf
  v_add_f32_dpp v23, v19, v19 row_ror:8 row_mask:0xf bank_mask:0xf
  v_add_f32_dpp v22, v20, v20 row_ror:8 row_mask:0xf bank_mask:0xc
  v_add_f32_dpp v23, v21, v21 row_ror:8 row_mask:0xf bank_mask:0xc
  buffer_load_dwordx4 v[144:147], v9, s[28:31], s72 offen nt
  s_addk_i32 s72, 0x1000
  s_cmp_ge_u32 s72, s14
  s_cselect_b32 s72, 0, s72
  s_nop 0
  v_add_f32_dpp v27, v22, v22 row_ror:12 row_mask:0xf bank_mask:0x5
  v_add_f32_dpp v27, v23, v23 row_ror:4 row_mask:0xf bank_mask:0xa
  buffer_load_dwordx4 v[148:151], v9, s[28:31], s72 offen nt
  s_addk_i32 s72, 0x1000
  s_cmp_ge_u32 s72, s14
  s_cselect_b32 s72, 0, s72
  s_nop 0
  v_add_f32_dpp v27, v27, v27 quad_perm:[1,0,3,2] row_mask:0xf bank_mask:0xf
  buffer_load_dwordx4 v[152:155], v9, s[28:31], s72 offen nt
  s_addk_i32 s72, 0x1000
  s_cmp_ge_u32 s72, s14
  s_cselect_b32 s72, 0, s72
  s_nop 0
  v_add_f32_dpp v89, v27, v27 quad_perm:[2,3,0,1] row_mask:0xf bank_mask:0xf
  buffer_load_dwordx4 v[156:159], v9, s[28:31], s72 offen nt
  s_addk_i32 s72, 0x1000
  s_cmp_ge_u32 s72, s14
  s_cselect_b32 s72, 0, s72
  v_max_f32 v24, v24, v89
  buffer_load_ushort v112, v62, s[48:51], 0 offen offset:0
  buffer_load_ushort v113, v62, s[48:51], 0 offen offset:16
  buffer_load_ushort v114, v62, s[48:51], 0 offen offset:32
  buffer_load_ushort v115, v62, s[48:51], 0 offen offset:48
  s_waitcnt vmcnt(44)
  v_dot2_f32_bf16 v18, v160, v14, 0
  v_dot2_f32_bf16 v19, v164, v14, 0
  v_dot2_f32_bf16 v20, v168, v14, 0
  v_dot2_f32_bf16 v21, v172, v14, 0
  v_dot2c_f32_bf16 v18, v161, v15
  v_dot2c_f32_bf16 v19, v165, v15
  v_dot2c_f32_bf16 v20, v169, v15
  v_dot2c_f32_bf16 v21, v173, v15
  v_dot2c_f32_bf16 v18, v162, v16
  v_dot2c_f32_bf16 v19, v166, v16
  v_dot2c_f32_bf16 v20, v170, v16
  v_dot2c_f32_bf16 v21, v174, v16
  v_dot2c_f32_bf16 v18, v163, v17
  v_dot2c_f32_bf16 v19, v167, v17
  v_dot2c_f32_bf16 v20, v171, v17
  v_dot2c_f32_bf16 v21, v175, v17
  v_add_f32_dpp v22, v18, v18 row_ror:8 row_mask:0xf bank_mask:0xf
  v_add_f32_dpp v23, v19, v19 row_ror:8 row_mask:0xf bank_mask:0xf
  v_add_f32_dpp v22, v20, v20 row_ror:8 row_mask:0xf bank_mask:0xc
  v_add_f32_dpp v23, v21, v21 row_ror:8 row_mask:0xf bank_mask:0xc
  buffer_load_dwordx4 v[160:163], v9, s[28:31], s72 offen nt
  s_addk_i32 s72, 0x1000
  s_cmp_ge_u32 s72, s14
  s_cselect_b32 s72, 0, s72
  s_nop 0
  v_add_f32_dpp v27, v22, v22 row_ror:12 row_mask:0xf bank_mask:0x5
  v_add_f32_dpp v27, v23, v23 row_ror:4 row_mask:0xf bank_mask:0xa
  buffer_load_dwordx4 v[164:167], v9, s[28:31], s72 offen nt
  s_addk_i32 s72, 0x1000
  s_cmp_ge_u32 s72, s14
  s_cselect_b32 s72, 0, s72
  s_nop 0
  v_add_f32_dpp v27, v27, v27 quad_perm:[1,0,3,2] row_mask:0xf bank_mask:0xf
  buffer_load_dwordx4 v[168:171], v9, s[28:31], s72 offen nt
  s_addk_i32 s72, 0x1000
  s_cmp_ge_u32 s72, s14
  s_cselect_b32 s72, 0, s72
  s_nop 0
  v_add_f32_dpp v90, v27, v27 quad_perm:[2,3,0,1] row_mask:0xf bank_mask:0xf
  buffer_load_dwordx4 v[172:175], v9, s[28:31], s72 offen nt
  s_addk_i32 s72, 0x1000
  s_cmp_ge_u32 s72, s14
  s_cselect_b32 s72, 0, s72
  v_max_f32 v24, v24, v90
  s_cmp_eq_u32 s64, 0
  s_cselect_b32 s79, 0, 1073741824
  v_mov_b32 v53, s79
  v_mov_b32 v126, 0
  s_mov_b64 exec, 1
  buffer_load_dword v126, v53, s[56:59], 0 offen sc1
  s_mov_b64 exec, -1
  s_waitcnt vmcnt(43)
  v_dot2_f32_bf16 v18, v176, v14, 0
  v_dot2_f32_bf16 v19, v180, v14, 0
  v_dot2_f32_bf16 v20, v184, v14, 0
  v_dot2_f32_bf16 v21, v188, v14, 0
  v_dot2c_f32_bf16 v18, v177, v15
  v_dot2c_f32_bf16 v19, v181, v15
  v_dot2c_f32_bf16 v20, v185, v15
  v_dot2c_f32_bf16 v21, v189, v15
  v_dot2c_f32_bf16 v18, v178, v16
  v_dot2c_f32_bf16 v19, v182, v16
  v_dot2c_f32_bf16 v20, v186, v16
  v_dot2c_f32_bf16 v21, v190, v16
  v_dot2c_f32_bf16 v18, v179, v17
  v_dot2c_f32_bf16 v19, v183, v17
  v_dot2c_f32_bf16 v20, v187, v17
  v_dot2c_f32_bf16 v21, v191, v17
  v_add_f32_dpp v22, v18, v18 row_ror:8 row_mask:0xf bank_mask:0xf
  v_add_f32_dpp v23, v19, v19 row_ror:8 row_mask:0xf bank_mask:0xf
  v_add_f32_dpp v22, v20, v20 row_ror:8 row_mask:0xf bank_mask:0xc
  v_add_f32_dpp v23, v21, v21 row_ror:8 row_mask:0xf bank_mask:0xc
  buffer_load_dwordx4 v[176:179], v9, s[28:31], s72 offen nt
  s_addk_i32 s72, 0x1000
  s_cmp_ge_u32 s72, s14
  s_cselect_b32 s72, 0, s72
  s_nop 0
  v_add_f32_dpp v27, v22, v22 row_ror:12 row_mask:0xf bank_mask:0x5
  v_add_f32_dpp v27, v23, v23 row_ror:4 row_mask:0xf bank_mask:0xa
  buffer_load_dwordx4 v[180:183], v9, s[28:31], s72 offen nt
  s_addk_i32 s72, 0x1000
  s_cmp_ge_u32 s72, s14
  s_cselect_b32 s72, 0, s72
  s_nop 0
  v_add_f32_dpp v27, v27, v27 quad_perm:[1,0,3,2] row_mask:0xf bank_mask:0xf
  buffer_load_dwordx4 v[184:187], v9, s[28:31], s72 offen nt
  s_addk_i32 s72, 0x1000
  s_cmp_ge_u32 s72, s14
  s_cselect_b32 s72, 0, s72
  s_nop 0
  v_add_f32_dpp v91, v27, v27 quad_perm:[2,3,0,1] row_mask:0xf bank_mask:0xf
  buffer_load_dwordx4 v[188:191], v9, s[28:31], s72 offen nt
  s_addk_i32 s72, 0x1000
  s_cmp_ge_u32 s72, s14
  s_cselect_b32 s72, 0, s72
  v_max_f32 v24, v24, v91
  s_waitcnt vmcnt(41)
  v_dot2_f32_bf16 v18, v192, v14, 0
  v_dot2_f32_bf16 v19, v196, v14, 0
  v_dot2_f32_bf16 v20, v200, v14, 0
  v_dot2_f32_bf16 v21, v204, v14, 0
  v_dot2c_f32_bf16 v18, v193, v15
  v_dot2c_f32_bf16 v19, v197, v15
  v_dot2c_f32_bf16 v20, v201, v15
  v_dot2c_f32_bf16 v21, v205, v15
  v_dot2c_f32_bf16 v18, v194, v16
  v_dot2c_f32_bf16 v19, v198, v16
  v_dot2c_f32_bf16 v20, v202, v16
  v_dot2c_f32_bf16 v21, v206, v16
  v_dot2c_f32_bf16 v18, v195, v17
  v_dot2c_f32_bf16 v19, v199, v17
  v_dot2c_f32_bf16 v20, v203, v17
  v_dot2c_f32_bf16 v21, v207, v17
  v_add_f32_dpp v22, v18, v18 row_ror:8 row_mask:0xf bank_mask:0xf
  v_add_f32_dpp v23, v19, v19 row_ror:8 row_mask:0xf bank_mask:0xf
  v_add_f32_dpp v22, v20, v20 row_ror:8 row_mask:0xf bank_mask:0xc
  v_add_f32_dpp v23, v21, v21 row_ror:8 row_mask:0xf bank_mask:0xc
  buffer_load_dwordx4 v[192:195], v9, s[28:31], s72 offen nt
  s_addk_i32 s72, 0x1000
  s_cmp_ge_u32 s72, s14
  s_cselect_b32 s72, 0, s72
  s_nop 0
  v_add_f32_dpp v27, v22, v22 row_ror:12 row_mask:0xf bank_mask:0x5
  v_add_f32_dpp v27, v23, v23 row_ror:4 row_mask:0xf bank_mask:0xa
  buffer_load_dwordx4 v[196:199], v9, s[28:31], s72 offen nt
  s_addk_i32 s72, 0x1000
  s_cmp_ge_u32 s72, s14
  s_cselect_b32 s72, 0, s72
  s_nop 0
  v_add_f32_dpp v27, v27, v27 quad_perm:[1,0,3,2] row_mask:0xf bank_mask:0xf
  buffer_load_dwordx4 v[200:203], v9, s[28:31], s72 offen nt
  s_addk_i32 s72, 0x1000
  s_cmp_ge_u32 s72, s14
  s_cselect_b32 s72, 0, s72
  s_nop 0
  v_add_f32_dpp v92, v27, v27 quad_perm:[2,3,0,1] row_mask:0xf bank_mask:0xf
  buffer_load_dwordx4 v[204:207], v9, s[28:31], s72 offen nt
  s_addk_i32 s72, 0x1000
  s_cmp_ge_u32 s72, s14
  s_cselect_b32 s72, 0, s72
  v_max_f32 v24, v24, v92
  s_waitcnt vmcnt(39)
  v_dot2_f32_bf16 v18, v208, v14, 0
  v_dot2_f32_bf16 v19, v212, v14, 0
  v_dot2_f32_bf16 v20, v216, v14, 0
  v_dot2_f32_bf16 v21, v220, v14, 0
  v_dot2c_f32_bf16 v18, v209, v15
  v_dot2c_f32_bf16 v19, v213, v15
  v_dot2c_f32_bf16 v20, v217, v15
  v_dot2c_f32_bf16 v21, v221, v15
  v_dot2c_f32_bf16 v18, v210, v16
  v_dot2c_f32_bf16 v19, v214, v16
  v_dot2c_f32_bf16 v20, v218, v16
  v_dot2c_f32_bf16 v21, v222, v16
  v_dot2c_f32_bf16 v18, v211, v17
  v_dot2c_f32_bf16 v19, v215, v17
  v_dot2c_f32_bf16 v20, v219, v17
  v_dot2c_f32_bf16 v21, v223, v17
  v_add_f32_dpp v22, v18, v18 row_ror:8 row_mask:0xf bank_mask:0xf
  v_add_f32_dpp v23, v19, v19 row_ror:8 row_mask:0xf bank_mask:0xf
  v_add_f32_dpp v22, v20, v20 row_ror:8 row_mask:0xf bank_mask:0xc
  v_add_f32_dpp v23, v21, v21 row_ror:8 row_mask:0xf bank_mask:0xc
  buffer_load_dwordx4 v[208:211], v9, s[28:31], s72 offen nt
  s_addk_i32 s72, 0x1000
  s_cmp_ge_u32 s72, s14
  s_cselect_b32 s72, 0, s72
  s_nop 0
  v_add_f32_dpp v27, v22, v22 row_ror:12 row_mask:0xf bank_mask:0x5
  v_add_f32_dpp v27, v23, v23 row_ror:4 row_mask:0xf bank_mask:0xa
  buffer_load_dwordx4 v[212:215], v9, s[28:31], s72 offen nt
  s_addk_i32 s72, 0x1000
  s_cmp_ge_u32 s72, s14
  s_cselect_b32 s72, 0, s72
  s_nop 0
  v_add_f32_dpp v27, v27, v27 quad_perm:[1,0,3,2] row_mask:0xf bank_mask:0xf
  buffer_load_dwordx4 v[216:219], v9, s[28:31], s72 offen nt
  s_addk_i32 s72, 0x1000
  s_cmp_ge_u32 s72, s14
  s_cselect_b32 s72, 0, s72
  s_nop 0
  v_add_f32_dpp v93, v27, v27 quad_perm:[2,3,0,1] row_mask:0xf bank_mask:0xf
  buffer_load_dwordx4 v[220:223], v9, s[28:31], s72 offen nt
  s_addk_i32 s72, 0x1000
  s_cmp_ge_u32 s72, s14
  s_cselect_b32 s72, 0, s72
  v_max_f32 v24, v24, v93
  s_waitcnt vmcnt(37)
  v_dot2_f32_bf16 v18, v224, v14, 0
  v_dot2_f32_bf16 v19, v228, v14, 0
  v_dot2_f32_bf16 v20, v232, v14, 0
  v_dot2_f32_bf16 v21, v236, v14, 0
  v_dot2c_f32_bf16 v18, v225, v15
  v_dot2c_f32_bf16 v19, v229, v15
  v_dot2c_f32_bf16 v20, v233, v15
  v_dot2c_f32_bf16 v21, v237, v15
  v_dot2c_f32_bf16 v18, v226, v16
  v_dot2c_f32_bf16 v19, v230, v16
  v_dot2c_f32_bf16 v20, v234, v16
  v_dot2c_f32_bf16 v21, v238, v16
  v_dot2c_f32_bf16 v18, v227, v17
  v_dot2c_f32_bf16 v19, v231, v17
  v_dot2c_f32_bf16 v20, v235, v17
  v_dot2c_f32_bf16 v21, v239, v17
  v_add_f32_dpp v22, v18, v18 row_ror:8 row_mask:0xf bank_mask:0xf
  v_add_f32_dpp v23, v19, v19 row_ror:8 row_mask:0xf bank_mask:0xf
  v_add_f32_dpp v22, v20, v20 row_ror:8 row_mask:0xf bank_mask:0xc
  v_add_f32_dpp v23, v21, v21 row_ror:8 row_mask:0xf bank_mask:0xc
  buffer_load_dwordx4 v[224:227], v9, s[28:31], s72 offen nt
  s_addk_i32 s72, 0x1000
  s_cmp_ge_u32 s72, s14
  s_cselect_b32 s72, 0, s72
  s_nop 0
  v_add_f32_dpp v27, v22, v22 row_ror:12 row_mask:0xf bank_mask:0x5
  v_add_f32_dpp v27, v23, v23 row_ror:4 row_mask:0xf bank_mask:0xa
  buffer_load_dwordx4 v[228:231], v9, s[28:31], s72 offen nt
  s_addk_i32 s72, 0x1000
  s_cmp_ge_u32 s72, s14
  s_cselect_b32 s72, 0, s72
  s_nop 0
  v_add_f32_dpp v27, v27, v27 quad_perm:[1,0,3,2] row_mask:0xf bank_mask:0xf
  buffer_load_dwordx4 v[232:235], v9, s[28:31], s72 offen nt
  s_addk_i32 s72, 0x1000
  s_cmp_ge_u32 s72, s14
  s_cselect_b32 s72, 0, s72
  s_nop 0
  v_add_f32_dpp v94, v27, v27 quad_perm:[2,3,0,1] row_mask:0xf bank_mask:0xf
  buffer_load_dwordx4 v[236:239], v9, s[28:31], s72 offen nt
  s_addk_i32 s72, 0x1000
  s_cmp_ge_u32 s72, s14
  s_cselect_b32 s72, 0, s72
  v_max_f32 v24, v24, v94
  s_waitcnt vmcnt(35)
  v_dot2_f32_bf16 v18, v240, v14, 0
  v_dot2_f32_bf16 v19, v244, v14, 0
  v_dot2_f32_bf16 v20, v248, v14, 0
  v_dot2_f32_bf16 v21, v252, v14, 0
  v_dot2c_f32_bf16 v18, v241, v15
  v_dot2c_f32_bf16 v19, v245, v15
  v_dot2c_f32_bf16 v20, v249, v15
  v_dot2c_f32_bf16 v21, v253, v15
  v_dot2c_f32_bf16 v18, v242, v16
  v_dot2c_f32_bf16 v19, v246, v16
  v_dot2c_f32_bf16 v20, v250, v16
  v_dot2c_f32_bf16 v21, v254, v16
  v_dot2c_f32_bf16 v18, v243, v17
  v_dot2c_f32_bf16 v19, v247, v17
  v_dot2c_f32_bf16 v20, v251, v17
  v_dot2c_f32_bf16 v21, v255, v17
  v_add_f32_dpp v22, v18, v18 row_ror:8 row_mask:0xf bank_mask:0xf
  v_add_f32_dpp v23, v19, v19 row_ror:8 row_mask:0xf bank_mask:0xf
  v_add_f32_dpp v22, v20, v20 row_ror:8 row_mask:0xf bank_mask:0xc
  v_add_f32_dpp v23, v21, v21 row_ror:8 row_mask:0xf bank_mask:0xc
  buffer_load_dwordx4 v[240:243], v9, s[28:31], s72 offen nt
  s_addk_i32 s72, 0x1000
  s_cmp_ge_u32 s72, s14
  s_cselect_b32 s72, 0, s72
  s_nop 0
  v_add_f32_dpp v27, v22, v22 row_ror:12 row_mask:0xf bank_mask:0x5
  v_add_f32_dpp v27, v23, v23 row_ror:4 row_mask:0xf bank_mask:0xa
  buffer_load_dwordx4 v[244:247], v9, s[28:31], s72 offen nt
  s_addk_i32 s72, 0x1000
  s_cmp_ge_u32 s72, s14
  s_cselect_b32 s72, 0, s72
  s_nop 0
  v_add_f32_dpp v27, v27, v27 quad_perm:[1,0,3,2] row_mask:0xf bank_mask:0xf
  buffer_load_dwordx4 v[248:251], v9, s[28:31], s72 offen nt
  s_addk_i32 s72, 0x1000
  s_cmp_ge_u32 s72, s14
  s_cselect_b32 s72, 0, s72
  s_nop 0
  v_add_f32_dpp v95, v27, v27 quad_perm:[2,3,0,1] row_mask:0xf bank_mask:0xf
  buffer_load_dwordx4 v[252:255], v9, s[28:31], s72 offen nt
  s_addk_i32 s72, 0x1000
  s_cmp_ge_u32 s72, s14
  s_cselect_b32 s72, 0, s72
  v_max_f32 v24, v24, v95
  s_waitcnt vmcnt(33)
  v_dot2_f32_bf16 v18, v128, v14, 0
  v_dot2_f32_bf16 v19, v132, v14, 0
  v_dot2_f32_bf16 v20, v136, v14, 0
  v_dot2_f32_bf16 v21, v140, v14, 0
  v_dot2c_f32_bf16 v18, v129, v15
  v_dot2c_f32_bf16 v19, v133, v15
  v_dot2c_f32_bf16 v20, v137, v15
  v_dot2c_f32_bf16 v21, v141, v15
  v_dot2c_f32_bf16 v18, v130, v16
  v_dot2c_f32_bf16 v19, v134, v16
  v_dot2c_f32_bf16 v20, v138, v16
  v_dot2c_f32_bf16 v21, v142, v16
  v_dot2c_f32_bf16 v18, v131, v17
  v_dot2c_f32_bf16 v19, v135, v17
  v_dot2c_f32_bf16 v20, v139, v17
  v_dot2c_f32_bf16 v21, v143, v17
  v_add_f32_dpp v22, v18, v18 row_ror:8 row_mask:0xf bank_mask:0xf
  v_add_f32_dpp v23, v19, v19 row_ror:8 row_mask:0xf bank_mask:0xf
  v_add_f32_dpp v22, v20, v20 row_ror:8 row_mask:0xf bank_mask:0xc
  v_add_f32_dpp v23, v21, v21 row_ror:8 row_mask:0xf bank_mask:0xc
  buffer_load_dwordx4 v[128:131], v9, s[28:31], s72 offen nt
  s_addk_i32 s72, 0x1000
  s_cmp_ge_u32 s72, s14
  s_cselect_b32 s72, 0, s72
  s_nop 0
  v_add_f32_dpp v27, v22, v22 row_ror:12 row_mask:0xf bank_mask:0x5
  v_add_f32_dpp v27, v23, v23 row_ror:4 row_mask:0xf bank_mask:0xa
  buffer_load_dwordx4 v[132:135], v9, s[28:31], s72 offen nt
  s_addk_i32 s72, 0x1000
  s_cmp_ge_u32 s72, s14
  s_cselect_b32 s72, 0, s72
  s_nop 0
  v_add_f32_dpp v27, v27, v27 quad_perm:[1,0,3,2] row_mask:0xf bank_mask:0xf
  buffer_load_dwordx4 v[136:139], v9, s[28:31], s72 offen nt
  s_addk_i32 s72, 0x1000
  s_cmp_ge_u32 s72, s14
  s_cselect_b32 s72, 0, s72
  s_nop 0
  v_add_f32_dpp v96, v27, v27 quad_perm:[2,3,0,1] row_mask:0xf bank_mask:0xf
  buffer_load_dwordx4 v[140:143], v9, s[28:31], s72 offen nt
  s_addk_i32 s72, 0x1000
  s_cmp_ge_u32 s72, s14
  s_cselect_b32 s72, 0, s72
  v_max_f32 v24, v24, v96
  s_nop 1
  v_max_f32_dpp v24, v24, v24 quad_perm:[1,0,3,2] row_mask:0xf bank_mask:0xf
  s_nop 1
  v_max_f32_dpp v24, v24, v24 quad_perm:[2,3,0,1] row_mask:0xf bank_mask:0xf
  s_nop 1
  v_max_f32_dpp v24, v24, v24 row_ror:4 row_mask:0xf bank_mask:0xf
  s_nop 1
  v_max_f32_dpp v24, v24, v24 row_ror:8 row_mask:0xf bank_mask:0xf
  s_nop 0
  v_readlane_b32 s74, v24, 0
  v_readlane_b32 s75, v24, 16
  v_readlane_b32 s76, v24, 32
  v_readlane_b32 s77, v24, 48
  s_nop 1
  v_mov_b32 v24, s74
  v_max_f32 v24, s75, v24
  v_max_f32 v24, s76, v24
  v_max_f32 v24, s77, v24
  v_cvt_pk_bf16_f32 v58, v24, v24
  v_and_b32 v58, 0xffff0000, v58
  v_mul_f32 v58, 0x3db504f3, v58
  v_cvt_pk_bf16_f32 v58, v58, v58
  v_and_b32 v58, 0xffff0000, v58
  v_mul_f32 v59, 0xbfb8aa3b, v58
  s_mov_b32 s78, 0x3db504f3
  v_mov_b32 v25, 0
  v_cvt_pk_bf16_f32 v64, v64, v64
  v_cvt_pk_bf16_f32 v65, v65, v65
  v_cvt_pk_bf16_f32 v66, v66, v66
  v_cvt_pk_bf16_f32 v67, v67, v67
  v_and_b32 v64, 0xffff0000, v64
  v_and_b32 v65, 0xffff0000, v65
  v_and_b32 v66, 0xffff0000, v66
  v_and_b32 v67, 0xffff0000, v67
  v_mul_f32 v64, s78, v64
  v_mul_f32 v65, s78, v65
  v_mul_f32 v66, s78, v66
  v_mul_f32 v67, s78, v67
  v_cvt_pk_bf16_f32 v64, v64, v64
  v_cvt_pk_bf16_f32 v65, v65, v65
  v_cvt_pk_bf16_f32 v66, v66, v66
  v_cvt_pk_bf16_f32 v67, v67, v67
  v_and_b32 v64, 0xffff0000, v64
  v_and_b32 v65, 0xffff0000, v65
  v_and_b32 v66, 0xffff0000, v66
  v_and_b32 v67, 0xffff0000, v67
  v_fma_f32 v64, v64, s82, v59
  v_fma_f32 v65, v65, s82, v59
  v_fma_f32 v66, v66, s82, v59
  v_fma_f32 v67, v67, s82, v59
  v_exp_f32 v64, v64
  v_exp_f32 v65, v65
  v_exp_f32 v66, v66
  v_exp_f32 v67, v67
  v_add_f32 v25, v25, v64
  v_add_f32 v25, v25, v65
  v_add_f32 v25, v25, v66
  v_add_f32 v25, v25, v67
  v_cvt_pk_bf16_f32 v64, v64, v64
  v_cvt_pk_bf16_f32 v65, v65, v65
  v_cvt_pk_bf16_f32 v66, v66, v66
  v_cvt_pk_bf16_f32 v67, v67, v67
  v_cvt_pk_bf16_f32 v68, v68, v68
  v_cvt_pk_bf16_f32 v69, v69, v69
  v_cvt_pk_bf16_f32 v70, v70, v70
  v_cvt_pk_bf16_f32 v71, v71, v71
  v_and_b32 v68, 0xffff0000, v68
  v_and_b32 v69, 0xffff0000, v69
  v_and_b32 v70, 0xffff0000, v70
  v_and_b32 v71, 0xffff0000, v71
  v_mul_f32 v68, s78, v68
  v_mul_f32 v69, s78, v69
  v_mul_f32 v70, s78, v70
  v_mul_f32 v71, s78, v71
  v_cvt_pk_bf16_f32 v68, v68, v68
  v_cvt_pk_bf16_f32 v69, v69, v69
  v_cvt_pk_bf16_f32 v70, v70, v70
  v_cvt_pk_bf16_f32 v71, v71, v71
  v_and_b32 v68, 0xffff0000, v68
  v_and_b32 v69, 0xffff0000, v69
  v_and_b32 v70, 0xffff0000, v70
  v_and_b32 v71, 0xffff0000, v71
  v_fma_f32 v68, v68, s82, v59
  v_fma_f32 v69, v69, s82, v59
  v_fma_f32 v70, v70, s82, v59
  v_fma_f32 v71, v71, s82, v59
  v_exp_f32 v68, v68
  v_exp_f32 v69, v69
  v_exp_f32 v70, v70
  v_exp_f32 v71, v71
  v_add_f32 v25, v25, v68
  v_add_f32 v25, v25, v69
  v_add_f32 v25, v25, v70
  v_add_f32 v25, v25, v71
  v_cvt_pk_bf16_f32 v68, v68, v68
  v_cvt_pk_bf16_f32 v69, v69, v69
  v_cvt_pk_bf16_f32 v70, v70, v70
  v_cvt_pk_bf16_f32 v71, v71, v71
  v_cvt_pk_bf16_f32 v72, v72, v72
  v_cvt_pk_bf16_f32 v73, v73, v73
  v_cvt_pk_bf16_f32 v74, v74, v74
  v_cvt_pk_bf16_f32 v75, v75, v75
  v_and_b32 v72, 0xffff0000, v72
  v_and_b32 v73, 0xffff0000, v73
  v_and_b32 v74, 0xffff0000, v74
  v_and_b32 v75, 0xffff0000, v75
  v_mul_f32 v72, s78, v72
  v_mul_f32 v73, s78, v73
  v_mul_f32 v74, s78, v74
  v_mul_f32 v75, s78, v75
  v_cvt_pk_bf16_f32 v72, v72, v72
  v_cvt_pk_bf16_f32 v73, v73, v73
  v_cvt_pk_bf16_f32 v74, v74, v74
  v_cvt_pk_bf16_f32 v75, v75, v75
  v_and_b32 v72, 0xffff0000, v72
  v_and_b32 v73, 0xffff0000, v73
  v_and_b32 v74, 0xffff0000, v74
  v_and_b32 v75, 0xffff0000, v75
  v_fma_f32 v72, v72, s82, v59
  v_fma_f32 v73, v73, s82, v59
  v_fma_f32 v74, v74, s82, v59
  v_fma_f32 v75, v75, s82, v59
  v_exp_f32 v72, v72
  v_exp_f32 v73, v73
  v_exp_f32 v74, v74
  v_exp_f32 v75, v75
  v_add_f32 v25, v25, v72
  v_add_f32 v25, v25, v73
  v_add_f32 v25, v25, v74
  v_add_f32 v25, v25, v75
  v_cvt_pk_bf16_f32 v72, v72, v72
  v_cvt_pk_bf16_f32 v73, v73, v73
  v_cvt_pk_bf16_f32 v74, v74, v74
  v_cvt_pk_bf16_f32 v75, v75, v75
  v_cvt_pk_bf16_f32 v76, v76, v76
  v_cvt_pk_bf16_f32 v77, v77, v77
  v_cvt_pk_bf16_f32 v78, v78, v78
  v_cvt_pk_bf16_f32 v79, v79, v79
  v_and_b32 v76, 0xffff0000, v76
  v_and_b32 v77, 0xffff0000, v77
  v_and_b32 v78, 0xffff0000, v78
  v_and_b32 v79, 0xffff0000, v79
  v_mul_f32 v76, s78, v76
  v_mul_f32 v77, s78, v77
  v_mul_f32 v78, s78, v78
  v_mul_f32 v79, s78, v79
  v_cvt_pk_bf16_f32 v76, v76, v76
  v_cvt_pk_bf16_f32 v77, v77, v77
  v_cvt_pk_bf16_f32 v78, v78, v78
  v_cvt_pk_bf16_f32 v79, v79, v79
  v_and_b32 v76, 0xffff0000, v76
  v_and_b32 v77, 0xffff0000, v77
  v_and_b32 v78, 0xffff0000, v78
  v_and_b32 v79, 0xffff0000, v79
  v_fma_f32 v76, v76, s82, v59
  v_fma_f32 v77, v77, s82, v59
  v_fma_f32 v78, v78, s82, v59
  v_fma_f32 v79, v79, s82, v59
  v_exp_f32 v76, v76
  v_exp_f32 v77, v77
  v_exp_f32 v78, v78
  v_exp_f32 v79, v79
  v_add_f32 v25, v25, v76
  v_add_f32 v25, v25, v77
  v_add_f32 v25, v25, v78
  v_add_f32 v25, v25, v79
  v_cvt_pk_bf16_f32 v76, v76, v76
  v_cvt_pk_bf16_f32 v77, v77, v77
  v_cvt_pk_bf16_f32 v78, v78, v78
  v_cvt_pk_bf16_f32 v79, v79, v79
  v_cvt_pk_bf16_f32 v80, v80, v80
  v_cvt_pk_bf16_f32 v81, v81, v81
  v_cvt_pk_bf16_f32 v82, v82, v82
  v_cvt_pk_bf16_f32 v83, v83, v83
  v_and_b32 v80, 0xffff0000, v80
  v_and_b32 v81, 0xffff0000, v81
  v_and_b32 v82, 0xffff0000, v82
  v_and_b32 v83, 0xffff0000, v83
  v_mul_f32 v80, s78, v80
  v_mul_f32 v81, s78, v81
  v_mul_f32 v82, s78, v82
  v_mul_f32 v83, s78, v83
  v_cvt_pk_bf16_f32 v80, v80, v80
  v_cvt_pk_bf16_f32 v81, v81, v81
  v_cvt_pk_bf16_f32 v82, v82, v82
  v_cvt_pk_bf16_f32 v83, v83, v83
  v_and_b32 v80, 0xffff0000, v80
  v_and_b32 v81, 0xffff0000, v81
  v_and_b32 v82, 0xffff0000, v82
  v_and_b32 v83, 0xffff0000, v83
  v_fma_f32 v80, v80, s82, v59
  v_fma_f32 v81, v81, s82, v59
  v_fma_f32 v82, v82, s82, v59
  v_fma_f32 v83, v83, s82, v59
  v_exp_f32 v80, v80
  v_exp_f32 v81, v81
  v_exp_f32 v82, v82
  v_exp_f32 v83, v83
  v_add_f32 v25, v25, v80
  v_add_f32 v25, v25, v81
  v_add_f32 v25, v25, v82
  v_add_f32 v25, v25, v83
  v_cvt_pk_bf16_f32 v80, v80, v80
  v_cvt_pk_bf16_f32 v81, v81, v81
  v_cvt_pk_bf16_f32 v82, v82, v82
  v_cvt_pk_bf16_f32 v83, v83, v83
  v_cvt_pk_bf16_f32 v84, v84, v84
  v_cvt_pk_bf16_f32 v85, v85, v85
  v_cvt_pk_bf16_f32 v86, v86, v86
  v_cvt_pk_bf16_f32 v87, v87, v87
  v_and_b32 v84, 0xffff0000, v84
  v_and_b32 v85, 0xffff0000, v85
  v_and_b32 v86, 0xffff0000, v86
  v_and_b32 v87, 0xffff0000, v87
  v_mul_f32 v84, s78, v84
  v_mul_f32 v85, s78, v85
  v_mul_f32 v86, s78, v86
  v_mul_f32 v87, s78, v87
  v_cvt_pk_bf16_f32 v84, v84, v84
  v_cvt_pk_bf16_f32 v85, v85, v85
  v_cvt_pk_bf16_f32 v86, v86, v86
  v_cvt_pk_bf16_f32 v87, v87, v87
  v_and_b32 v84, 0xffff0000, v84
  v_and_b32 v85, 0xffff0000, v85
  v_and_b32 v86, 0xffff0000, v86
  v_and_b32 v87, 0xffff0000, v87
  v_fma_f32 v84, v84, s82, v59
  v_fma_f32 v85, v85, s82, v59
  v_fma_f32 v86, v86, s82, v59
  v_fma_f32 v87, v87, s82, v59
  v_exp_f32 v84, v84
  v_exp_f32 v85, v85
  v_exp_f32 v86, v86
  v_exp_f32 v87, v87
  v_add_f32 v25, v25, v84
  v_add_f32 v25, v25, v85
  v_add_f32 v25, v25, v86
  v_add_f32 v25, v25, v87
  v_cvt_pk_bf16_f32 v84, v84, v84
  v_cvt_pk_bf16_f32 v85, v85, v85
  v_cvt_pk_bf16_f32 v86, v86, v86
  v_cvt_pk_bf16_f32 v87, v87, v87
  v_cvt_pk_bf16_f32 v88, v88, v88
  v_cvt_pk_bf16_f32 v89, v89, v89
  v_cvt_pk_bf16_f32 v90, v90, v90
  v_cvt_pk_bf16_f32 v91, v91, v91
  v_and_b32 v88, 0xffff0000, v88
  v_and_b32 v89, 0xffff0000, v89
  v_and_b32 v90, 0xffff0000, v90
  v_and_b32 v91, 0xffff0000, v91
  v_mul_f32 v88, s78, v88
  v_mul_f32 v89, s78, v89
  v_mul_f32 v90, s78, v90
  v_mul_f32 v91, s78, v91
  v_cvt_pk_bf16_f32 v88, v88, v88
  v_cvt_pk_bf16_f32 v89, v89, v89
  v_cvt_pk_bf16_f32 v90, v90, v90
  v_cvt_pk_bf16_f32 v91, v91, v91
  v_and_b32 v88, 0xffff0000, v88
  v_and_b32 v89, 0xffff0000, v89
  v_and_b32 v90, 0xffff0000, v90
  v_and_b32 v91, 0xffff0000, v91
  v_fma_f32 v88, v88, s82, v59
  v_fma_f32 v89, v89, s82, v59
  v_fma_f32 v90, v90, s82, v59
  v_fma_f32 v91, v91, s82, v59
  v_exp_f32 v88, v88
  v_exp_f32 v89, v89
  v_exp_f32 v90, v90
  v_exp_f32 v91, v91
  v_add_f32 v25, v25, v88
  v_add_f32 v25, v25, v89
  v_add_f32 v25, v25, v90
  v_add_f32 v25, v25, v91
  v_cvt_pk_bf16_f32 v88, v88, v88
  v_cvt_pk_bf16_f32 v89, v89, v89
  v_cvt_pk_bf16_f32 v90, v90, v90
  v_cvt_pk_bf16_f32 v91, v91, v91
  v_cvt_pk_bf16_f32 v92, v92, v92
  v_cvt_pk_bf16_f32 v93, v93, v93
  v_cvt_pk_bf16_f32 v94, v94, v94
  v_cvt_pk_bf16_f32 v95, v95, v95
  v_and_b32 v92, 0xffff0000, v92
  v_and_b32 v93, 0xffff0000, v93
  v_and_b32 v94, 0xffff0000, v94
  v_and_b32 v95, 0xffff0000, v95
  v_mul_f32 v92, s78, v92
  v_mul_f32 v93, s78, v93
  v_mul_f32 v94, s78, v94
  v_mul_f32 v95, s78, v95
  v_cvt_pk_bf16_f32 v92, v92, v92
  v_cvt_pk_bf16_f32 v93, v93, v93
  v_cvt_pk_bf16_f32 v94, v94, v94
  v_cvt_pk_bf16_f32 v95, v95, v95
  v_and_b32 v92, 0xffff0000, v92
  v_and_b32 v93, 0xffff0000, v93
  v_and_b32 v94, 0xffff0000, v94
  v_and_b32 v95, 0xffff0000, v95
  v_fma_f32 v92, v92, s82, v59
  v_fma_f32 v93, v93, s82, v59
  v_fma_f32 v94, v94, s82, v59
  v_fma_f32 v95, v95, s82, v59
  v_exp_f32 v92, v92
  v_exp_f32 v93, v93
  v_exp_f32 v94, v94
  v_exp_f32 v95, v95
  v_add_f32 v25, v25, v92
  v_add_f32 v25, v25, v93
  v_add_f32 v25, v25, v94
  v_add_f32 v25, v25, v95
  v_cvt_pk_bf16_f32 v92, v92, v92
  v_cvt_pk_bf16_f32 v93, v93, v93
  v_cvt_pk_bf16_f32 v94, v94, v94
  v_cvt_pk_bf16_f32 v95, v95, v95
  v_cvt_pk_bf16_f32 v96, v96, v96
  v_and_b32 v96, 0xffff0000, v96
  v_mul_f32 v96, s78, v96
  v_cvt_pk_bf16_f32 v96, v96, v96
  v_and_b32 v96, 0xffff0000, v96
  v_fma_f32 v96, v96, s82, v59
  v_exp_f32 v96, v96
  s_nop 0
  v_add_f32 v25, v25, v96
  v_cvt_pk_bf16_f32 v96, v96, v96
  s_nop 1
  v_add_f32_dpp v25, v25, v25 quad_perm:[1,0,3,2] row_mask:0xf bank_mask:0xf
  s_nop 1
  v_add_f32_dpp v25, v25, v25 quad_perm:[2,3,0,1] row_mask:0xf bank_mask:0xf
  s_nop 1
  v_add_f32_dpp v25, v25, v25 row_ror:4 row_mask:0xf bank_mask:0xf
  s_nop 1
  v_add_f32_dpp v25, v25, v25 row_ror:8 row_mask:0xf bank_mask:0xf
  s_nop 0
  v_readlane_b32 s74, v25, 0
  v_readlane_b32 s75, v25, 16
  v_readlane_b32 s76, v25, 32
  v_readlane_b32 s77, v25, 48
  s_nop 1
  v_mov_b32 v25, s74
  v_add_f32 v25, s75, v25
  v_add_f32 v25, s76, v25
  v_add_f32 v25, s77, v25
  v_mul_f32 v25, 0x3e800000, v25
  v_and_b32_dpp v28, v7, v6 row_newbcast:0 row_mask:0xf bank_mask:0xf
  v_and_b32_dpp v29, v8, v6 row_newbcast:0 row_mask:0xf bank_mask:0xf
  v_and_b32_dpp v30, v7, v6 row_newbcast:1 row_mask:0xf bank_mask:0xf
  v_and_b32_dpp v31, v8, v6 row_newbcast:1 row_mask:0xf bank_mask:0xf
  s_nop 1
  v_mfma_f32_16x16x32_bf16 v[40:43], a[128:131], v[28:31], 0
  v_and_b32_dpp v32, v7, v6 row_newbcast:2 row_mask:0xf bank_mask:0xf
  v_and_b32_dpp v33, v8, v6 row_newbcast:2 row_mask:0xf bank_mask:0xf
  v_and_b32_dpp v34, v7, v6 row_newbcast:3 row_mask:0xf bank_mask:0xf
  v_and_b32_dpp v35, v8, v6 row_newbcast:3 row_mask:0xf bank_mask:0xf
  s_nop 1
  v_mfma_f32_16x16x32_bf16 v[40:43], a[132:135], v[32:35], v[40:43]
  v_and_b32_dpp v28, v7, v6 row_newbcast:4 row_mask:0xf bank_mask:0xf
  v_and_b32_dpp v29, v8, v6 row_newbcast:4 row_mask:0xf bank_mask:0xf
  v_and_b32_dpp v30, v7, v6 row_newbcast:5 row_mask:0xf bank_mask:0xf
  v_and_b32_dpp v31, v8, v6 row_newbcast:5 row_mask:0xf bank_mask:0xf
  s_nop 1
  v_mfma_f32_16x16x32_bf16 v[40:43], a[136:139], v[28:31], v[40:43]
  v_and_b32_dpp v32, v7, v6 row_newbcast:6 row_mask:0xf bank_mask:0xf
  v_and_b32_dpp v33, v8, v6 row_newbcast:6 row_mask:0xf bank_mask:0xf
  v_and_b32_dpp v34, v7, v6 row_newbcast:7 row_mask:0xf bank_mask:0xf
  v_and_b32_dpp v35, v8, v6 row_newbcast:7 row_mask:0xf bank_mask:0xf
  s_nop 1
  v_mfma_f32_16x16x32_bf16 v[40:43], a[140:143], v[32:35], v[40:43]
  v_and_b32_dpp v28, v7, v6 row_newbcast:8 row_mask:0xf bank_mask:0xf
  v_and_b32_dpp v29, v8, v6 row_newbcast:8 row_mask:0xf bank_mask:0xf
  v_and_b32_dpp v30, v7, v6 row_newbcast:9 row_mask:0xf bank_mask:0xf
  v_and_b32_dpp v31, v8, v6 row_newbcast:9 row_mask:0xf bank_mask:0xf
  s_nop 1
  v_mfma_f32_16x16x32_bf16 v[40:43], a[144:147], v[28:31], v[40:43]
  v_and_b32_dpp v32, v7, v6 row_newbcast:10 row_mask:0xf bank_mask:0xf
  v_and_b32_dpp v33, v8, v6 row_newbcast:10 row_mask:0xf bank_mask:0xf
  v_and_b32_dpp v34, v7, v6 row_newbcast:11 row_mask:0xf bank_mask:0xf
  v_and_b32_dpp v35, v8, v6 row_newbcast:11 row_mask:0xf bank_mask:0xf
  s_nop 1
  v_mfma_f32_16x16x32_bf16 v[40:43], a[148:151], v[32:35], v[40:43]
  v_and_b32_dpp v28, v7, v6 row_newbcast:12 row_mask:0xf bank_mask:0xf
  v_and_b32_dpp v29, v8, v6 row_newbcast:12 row_mask:0xf bank_mask:0xf
  v_and_b32_dpp v30, v7, v6 row_newbcast:13 row_mask:0xf bank_mask:0xf
  v_and_b32_dpp v31, v8, v6 row_newbcast:13 row_mask:0xf bank_mask:0xf
  s_nop 1
  v_mfma_f32_16x16x32_bf16 v[40:43], a[152:155], v[28:31], v[40:43]
  v_and_b32_dpp v32, v7, v6 row_newbcast:14 row_mask:0xf bank_mask:0xf
  v_and_b32_dpp v33, v8, v6 row_newbcast:14 row_mask:0xf bank_mask:0xf
  v_and_b32_dpp v34, v7, v6 row_newbcast:15 row_mask:0xf bank_mask:0xf
  v_and_b32_dpp v35, v8, v6 row_newbcast:15 row_mask:0xf bank_mask:0xf
  s_nop 1
  v_mfma_f32_16x16x32_bf16 v[40:43], a[156:159], v[32:35], v[40:43]
  s_lshl_b32 s74, s64, 7
  s_addk_i32 s74, 2048
  v_lshlrev_b32 v56, 5, v44
  v_lshl_add_u32 v56, v45, 2, v56
  v_add_u32 v56, s74, v56
  s_lshl_b32 s74, s64, 3
  s_addk_i32 s74, 2560
  v_mov_b32 v26, s74
  v_mov_b32 v24, v58
  s_nop 3
  s_mov_b32 exec_lo, 0x00030003
  s_mov_b32 exec_hi, 0x00030003
  ds_write_b32 v56, v40 offset:0
  ds_write_b32 v56, v41 offset:8
  ds_write_b32 v56, v42 offset:16
  ds_write_b32 v56, v43 offset:24
  s_mov_b64 exec, 1
  ds_write_b64 v26, v[24:25]
  s_mov_b64 exec, -1
  v_and_b32 v57, 7, v45
  v_lshl_add_u32 v57, v44, 3, v57
  v_lshlrev_b32 v57, 2, v57
  s_waitcnt vmcnt(24)
  s_cmp_lg_u32 s64, 0
  s_cbranch_scc1 L_zok
L_zchk:
  v_readfirstlane_b32 s74, v126
  s_nop 3
  s_cmp_ge_u32 s74, 48
  s_cbranch_scc1 L_zok
  s_sleep 8
  v_mov_b32 v126, 0
  s_mov_b64 exec, 1
  buffer_atomic_add v126, v53, s[56:59], 0 offen sc0
  s_waitcnt vmcnt(0)
  s_mov_b64 exec, -1
  s_branch L_zchk
L_zok:
  v_mov_b32 v26, 0
  s_waitcnt lgkmcnt(0)
  s_barrier
  ds_read_b32 v98, v57 offset:2048
  ds_read_b32 v99, v57 offset:2176
  ds_read_b32 v100, v57 offset:2304
  ds_read_b32 v101, v57 offset:2432
  ds_read_b128 v[102:105], v26 offset:2560
  ds_read_b128 v[106:109], v26 offset:2576
  s_waitcnt lgkmcnt(0)
  v_max_f32 v120, v102, v104
  v_max3_f32 v120, v120, v106, v108
  v_sub_f32 v102, v102, v120
  v_mul_f32 v102, s82, v102
  v_sub_f32 v104, v104, v120
  v_mul_f32 v104, s82, v104
  v_sub_f32 v106, v106, v120
  v_mul_f32 v106, s82, v106
  v_sub_f32 v108, v108, v120
  v_mul_f32 v108, s82, v108
  v_sub_f32 v122, v58, v120
  v_mul_f32 v122, s82, v122
  v_exp_f32 v102, v102
  v_exp_f32 v104, v104
  v_exp_f32 v106, v106
  v_exp_f32 v108, v108
  v_exp_f32 v122, v122
  v_mul_f32 v121, v102, v103
  v_fmac_f32 v121, v104, v105
  v_fmac_f32 v121, v106, v107
  v_fmac_f32 v121, v108, v109
  s_lshl_b32 s74, s66, 5
  s_add_u32 s74, s74, s65
  s_lshl_b32 s74, s74, 1
  s_add_u32 s74, s74, s67
  s_lshl_b32 s74, s74, 6
  s_add_u32 s74, s74, 32768
  s_xor_b32 s75, s74, 64
  s_cmp_eq_u32 s64, 0
  s_cselect_b32 s74, s74, 1073741824
  s_cselect_b32 s83, s75, 1073741824
  v_mov_b32 v53, s74
  s_mov_b64 exec, 1
  buffer_atomic_swap_x2 v[120:121], v53, s[52:55], 0 offen
  s_mov_b64 exec, -1
  v_add_f32 v98, v98, v99
  v_add_f32 v100, v100, v101
  v_add_f32 v98, v98, v100
  v_cvt_pk_bf16_f32 v98, v98, v98
  v_and_b32 v98, 0xffff0000, v98
  v_mul_f32 v99, 0xbfb8aa3b, v98
  v_exp_f32 v99, v99
  s_nop 0
  v_add_f32 v99, 1.0, v99
  v_rcp_f32 v99, v99
  s_nop 0
  v_mul_f32 v98, v98, v99
  v_cvt_pk_bf16_f32 v100, v98, v98
  s_nop 1
  v_and_b32_dpp v28, v100, v2 row_newbcast:0 row_mask:0xf bank_mask:0xf
  v_and_b32_dpp v29, v100, v3 row_newbcast:0 row_mask:0xf bank_mask:0xf
  v_and_b32_dpp v30, v100, v4 row_newbcast:0 row_mask:0xf bank_mask:0xf
  v_and_b32_dpp v31, v100, v5 row_newbcast:0 row_mask:0xf bank_mask:0xf
  s_nop 1
  v_mfma_f32_16x16x32_bf16 v[40:43], a[160:163], v[28:31], 0
  v_and_b32_dpp v32, v100, v2 row_newbcast:1 row_mask:0xf bank_mask:0xf
  v_and_b32_dpp v33, v100, v3 row_newbcast:1 row_mask:0xf bank_mask:0xf
  v_and_b32_dpp v34, v100, v4 row_newbcast:1 row_mask:0xf bank_mask:0xf
  v_and_b32_dpp v35, v100, v5 row_newbcast:1 row_mask:0xf bank_mask:0xf
  s_nop 1
  v_mfma_f32_16x16x32_bf16 v[40:43], a[164:167], v[32:35], v[40:43]
  v_and_b32_dpp v28, v100, v2 row_newbcast:2 row_mask:0xf bank_mask:0xf
  v_and_b32_dpp v29, v100, v3 row_newbcast:2 row_mask:0xf bank_mask:0xf
  v_and_b32_dpp v30, v100, v4 row_newbcast:2 row_mask:0xf bank_mask:0xf
  v_and_b32_dpp v31, v100, v5 row_newbcast:2 row_mask:0xf bank_mask:0xf
  s_nop 1
  v_mfma_f32_16x16x32_bf16 v[40:43], a[168:171], v[28:31], v[40:43]
  v_and_b32_dpp v32, v100, v2 row_newbcast:3 row_mask:0xf bank_mask:0xf
  v_and_b32_dpp v33, v100, v3 row_newbcast:3 row_mask:0xf bank_mask:0xf
  v_and_b32_dpp v34, v100, v4 row_newbcast:3 row_mask:0xf bank_mask:0xf
  v_and_b32_dpp v35, v100, v5 row_newbcast:3 row_mask:0xf bank_mask:0xf
  s_nop 1
  v_mfma_f32_16x16x32_bf16 v[40:43], a[172:175], v[32:35], v[40:43]
  v_and_b32_dpp v28, v100, v2 row_newbcast:4 row_mask:0xf bank_mask:0xf
  v_and_b32_dpp v29, v100, v3 row_newbcast:4 row_mask:0xf bank_mask:0xf
  v_and_b32_dpp v30, v100, v4 row_newbcast:4 row_mask:0xf bank_mask:0xf
  v_and_b32_dpp v31, v100, v5 row_newbcast:4 row_mask:0xf bank_mask:0xf
  s_nop 1
  v_mfma_f32_16x16x32_bf16 v[40:43], a[176:179], v[28:31], v[40:43]
  v_and_b32_dpp v32, v100, v2 row_newbcast:5 row_mask:0xf bank_mask:0xf
  v_and_b32_dpp v33, v100, v3 row_newbcast:5 row_mask:0xf bank_mask:0xf
  v_and_b32_dpp v34, v100, v4 row_newbcast:5 row_mask:0xf bank_mask:0xf
  v_and_b32_dpp v35, v100, v5 row_newbcast:5 row_mask:0xf bank_mask:0xf
  s_nop 1
  v_mfma_f32_16x16x32_bf16 v[40:43], a[180:183], v[32:35], v[40:43]
  v_and_b32_dpp v28, v100, v2 row_newbcast:6 row_mask:0xf bank_mask:0xf
  v_and_b32_dpp v29, v100, v3 row_newbcast:6 row_mask:0xf bank_mask:0xf
  v_and_b32_dpp v30, v100, v4 row_newbcast:6 row_mask:0xf bank_mask:0xf
  v_and_b32_dpp v31, v100, v5 row_newbcast:6 row_mask:0xf bank_mask:0xf
  s_nop 1
  v_mfma_f32_16x16x32_bf16 v[40:43], a[184:187], v[28:31], v[40:43]
  v_and_b32_dpp v32, v100, v2 row_newbcast:7 row_mask:0xf bank_mask:0xf
  v_and_b32_dpp v33, v100, v3 row_newbcast:7 row_mask:0xf bank_mask:0xf
  v_and_b32_dpp v34, v100, v4 row_newbcast:7 row_mask:0xf bank_mask:0xf
  v_and_b32_dpp v35, v100, v5 row_newbcast:7 row_mask:0xf bank_mask:0xf
  s_nop 1
  v_mfma_f32_16x16x32_bf16 v[40:43], a[188:191], v[32:35], v[40:43]
  s_mov_b32 s74, 16384
  s_nop 7
  v_cndmask_b32 v106, v40, 1.0, s[100:101]
  v_cndmask_b32 v107, v41, 1.0, s[100:101]
  v_cndmask_b32 v108, v42, 1.0, s[100:101]
  v_cndmask_b32 v109, v43, 1.0, s[100:101]
  v_and_b32_dpp v28, v64, v2 row_newbcast:0 row_mask:0xf bank_mask:0xf
  v_and_b32_dpp v29, v64, v3 row_newbcast:0 row_mask:0xf bank_mask:0xf
  v_and_b32_dpp v30, v64, v4 row_newbcast:0 row_mask:0xf bank_mask:0xf
  v_and_b32_dpp v31, v64, v5 row_newbcast:0 row_mask:0xf bank_mask:0xf
  v_and_b32_dpp v32, v64, v2 row_newbcast:4 row_mask:0xf bank_mask:0xf
  v_and_b32_dpp v33, v64, v3 row_newbcast:4 row_mask:0xf bank_mask:0xf
  v_and_b32_dpp v34, v64, v4 row_newbcast:4 row_mask:0xf bank_mask:0xf
  v_and_b32_dpp v35, v64, v5 row_newbcast:4 row_mask:0xf bank_mask:0xf
  v_mfma_f32_16x16x32_bf16 v[36:39], a[192:195], v[28:31], 0
  v_and_b32_dpp v28, v64, v2 row_newbcast:8 row_mask:0xf bank_mask:0xf
  v_and_b32_dpp v29, v64, v3 row_newbcast:8 row_mask:0xf bank_mask:0xf
  v_and_b32_dpp v30, v64, v4 row_newbcast:8 row_mask:0xf bank_mask:0xf
  v_and_b32_dpp v31, v64, v5 row_newbcast:8 row_mask:0xf bank_mask:0xf
  v_mfma_f32_16x16x32_bf16 v[36:39], a[196:199], v[32:35], v[36:39]
  v_and_b32_dpp v32, v64, v2 row_newbcast:12 row_mask:0xf bank_mask:0xf
  v_and_b32_dpp v33, v64, v3 row_newbcast:12 row_mask:0xf bank_mask:0xf
  v_and_b32_dpp v34, v64, v4 row_newbcast:12 row_mask:0xf bank_mask:0xf
  v_and_b32_dpp v35, v64, v5 row_newbcast:12 row_mask:0xf bank_mask:0xf
  v_mfma_f32_16x16x32_bf16 v[36:39], a[200:203], v[28:31], v[36:39]
  v_and_b32_dpp v28, v65, v2 row_newbcast:0 row_mask:0xf bank_mask:0xf
  v_and_b32_dpp v29, v65, v3 row_newbcast:0 row_mask:0xf bank_mask:0xf
  v_and_b32_dpp v30, v65, v4 row_newbcast:0 row_mask:0xf bank_mask:0xf
  v_and_b32_dpp v31, v65, v5 row_newbcast:0 row_mask:0xf bank_mask:0xf
  v_mfma_f32_16x16x32_bf16 v[36:39], a[204:207], v[32:35], v[36:39]
  v_and_b32_dpp v32, v65, v2 row_newbcast:4 row_mask:0xf bank_mask:0xf
  v_and_b32_dpp v33, v65, v3 row_newbcast:4 row_mask:0xf bank_mask:0xf
  v_and_b32_dpp v34, v65, v4 row_newbcast:4 row_mask:0xf bank_mask:0xf
  v_and_b32_dpp v35, v65, v5 row_newbcast:4 row_mask:0xf bank_mask:0xf
  v_mfma_f32_16x16x32_bf16 v[36:39], a[208:211], v[28:31], v[36:39]
  v_and_b32_dpp v28, v65, v2 row_newbcast:8 row_mask:0xf bank_mask:0xf
  v_and_b32_dpp v29, v65, v3 row_newbcast:8 row_mask:0xf bank_mask:0xf
  v_and_b32_dpp v30, v65, v4 row_newbcast:8 row_mask:0xf bank_mask:0xf
  v_and_b32_dpp v31, v65, v5 row_newbcast:8 row_mask:0xf bank_mask:0xf
  v_mfma_f32_16x16x32_bf16 v[36:39], a[212:215], v[32:35], v[36:39]
  v_and_b32_dpp v32, v65, v2 row_newbcast:12 row_mask:0xf bank_mask:0xf
  v_and_b32_dpp v33, v65, v3 row_newbcast:12 row_mask:0xf bank_mask:0xf
  v_and_b32_dpp v34, v65, v4 row_newbcast:12 row_mask:0xf bank_mask:0xf
  v_and_b32_dpp v35, v65, v5 row_newbcast:12 row_mask:0xf bank_mask:0xf
  v_mfma_f32_16x16x32_bf16 v[36:39], a[216:219], v[28:31], v[36:39]
  v_and_b32_dpp v28, v66, v2 row_newbcast:0 row_mask:0xf bank_mask:0xf
  v_and_b32_dpp v29, v66, v3 row_newbcast:0 row_mask:0xf bank_mask:0xf
  v_and_b32_dpp v30, v66, v4 row_newbcast:0 row_mask:0xf bank_mask:0xf
  v_and_b32_dpp v31, v66, v5 row_newbcast:0 row_mask:0xf bank_mask:0xf
  v_mfma_f32_16x16x32_bf16 v[36:39], a[220:223], v[32:35], v[36:39]
  v_and_b32_dpp v32, v66, v2 row_newbcast:4 row_mask:0xf bank_mask:0xf
  v_and_b32_dpp v33, v66, v3 row_newbcast:4 row_mask:0xf bank_mask:0xf
  v_and_b32_dpp v34, v66, v4 row_newbcast:4 row_mask:0xf bank_mask:0xf
  v_and_b32_dpp v35, v66, v5 row_newbcast:4 row_mask:0xf bank_mask:0xf
  v_mfma_f32_16x16x32_bf16 v[36:39], a[224:227], v[28:31], v[36:39]
  v_and_b32_dpp v28, v66, v2 row_newbcast:8 row_mask:0xf bank_mask:0xf
  v_and_b32_dpp v29, v66, v3 row_newbcast:8 row_mask:0xf bank_mask:0xf
  v_and_b32_dpp v30, v66, v4 row_newbcast:8 row_mask:0xf bank_mask:0xf
  v_and_b32_dpp v31, v66, v5 row_newbcast:8 row_mask:0xf bank_mask:0xf
  v_mfma_f32_16x16x32_bf16 v[36:39], a[228:231], v[32:35], v[36:39]
  v_and_b32_dpp v32, v66, v2 row_newbcast:12 row_mask:0xf bank_mask:0xf
  v_and_b32_dpp v33, v66, v3 row_newbcast:12 row_mask:0xf bank_mask:0xf
  v_and_b32_dpp v34, v66, v4 row_newbcast:12 row_mask:0xf bank_mask:0xf
  v_and_b32_dpp v35, v66, v5 row_newbcast:12 row_mask:0xf bank_mask:0xf
  v_mfma_f32_16x16x32_bf16 v[36:39], a[232:235], v[28:31], v[36:39]
  v_and_b32_dpp v28, v67, v2 row_newbcast:0 row_mask:0xf bank_mask:0xf
  v_and_b32_dpp v29, v67, v3 row_newbcast:0 row_mask:0xf bank_mask:0xf
  v_and_b32_dpp v30, v67, v4 row_newbcast:0 row_mask:0xf bank_mask:0xf
  v_and_b32_dpp v31, v67, v5 row_newbcast:0 row_mask:0xf bank_mask:0xf
  v_mfma_f32_16x16x32_bf16 v[36:39], a[236:239], v[32:35], v[36:39]
  v_and_b32_dpp v32, v67, v2 row_newbcast:4 row_mask:0xf bank_mask:0xf
  v_and_b32_dpp v33, v67, v3 row_newbcast:4 row_mask:0xf bank_mask:0xf
  v_and_b32_dpp v34, v67, v4 row_newbcast:4 row_mask:0xf bank_mask:0xf
  v_and_b32_dpp v35, v67, v5 row_newbcast:4 row_mask:0xf bank_mask:0xf
  v_mfma_f32_16x16x32_bf16 v[36:39], a[240:243], v[28:31], v[36:39]
  v_and_b32_dpp v28, v67, v2 row_newbcast:8 row_mask:0xf bank_mask:0xf
  v_and_b32_dpp v29, v67, v3 row_newbcast:8 row_mask:0xf bank_mask:0xf
  v_and_b32_dpp v30, v67, v4 row_newbcast:8 row_mask:0xf bank_mask:0xf
  v_and_b32_dpp v31, v67, v5 row_newbcast:8 row_mask:0xf bank_mask:0xf
  v_mfma_f32_16x16x32_bf16 v[36:39], a[244:247], v[32:35], v[36:39]
  v_and_b32_dpp v32, v67, v2 row_newbcast:12 row_mask:0xf bank_mask:0xf
  v_and_b32_dpp v33, v67, v3 row_newbcast:12 row_mask:0xf bank_mask:0xf
  v_and_b32_dpp v34, v67, v4 row_newbcast:12 row_mask:0xf bank_mask:0xf
  v_and_b32_dpp v35, v67, v5 row_newbcast:12 row_mask:0xf bank_mask:0xf
  v_mfma_f32_16x16x32_bf16 v[36:39], a[248:251], v[28:31], v[36:39]
  v_and_b32_dpp v28, v68, v2 row_newbcast:0 row_mask:0xf bank_mask:0xf
  v_and_b32_dpp v29, v68, v3 row_newbcast:0 row_mask:0xf bank_mask:0xf
  v_and_b32_dpp v30, v68, v4 row_newbcast:0 row_mask:0xf bank_mask:0xf
  v_and_b32_dpp v31, v68, v5 row_newbcast:0 row_mask:0xf bank_mask:0xf
  v_mfma_f32_16x16x32_bf16 v[36:39], a[252:255], v[32:35], v[36:39]
  v_and_b32_dpp v32, v68, v2 row_newbcast:4 row_mask:0xf bank_mask:0xf
  v_and_b32_dpp v33, v68, v3 row_newbcast:4 row_mask:0xf bank_mask:0xf
  v_and_b32_dpp v34, v68, v4 row_newbcast:4 row_mask:0xf bank_mask:0xf
  v_and_b32_dpp v35, v68, v5 row_newbcast:4 row_mask:0xf bank_mask:0xf
  v_mfma_f32_16x16x32_bf16 v[36:39], v[144:147], v[28:31], v[36:39]
  buffer_load_dwordx4 v[144:147], v9, s[28:31], s72 offen nt
  s_addk_i32 s72, 0x1000
  s_cmp_ge_u32 s72, s14
  s_cselect_b32 s72, 0, s72
  v_and_b32_dpp v28, v68, v2 row_newbcast:8 row_mask:0xf bank_mask:0xf
  v_and_b32_dpp v29, v68, v3 row_newbcast:8 row_mask:0xf bank_mask:0xf
  v_and_b32_dpp v30, v68, v4 row_newbcast:8 row_mask:0xf bank_mask:0xf
  v_and_b32_dpp v31, v68, v5 row_newbcast:8 row_mask:0xf bank_mask:0xf
  v_mfma_f32_16x16x32_bf16 v[36:39], v[148:151], v[32:35], v[36:39]
  buffer_load_dwordx4 v[148:151], v9, s[28:31], s72 offen nt
  s_addk_i32 s72, 0x1000
  s_cmp_ge_u32 s72, s14
  s_cselect_b32 s72, 0, s72
  v_and_b32_dpp v32, v68, v2 row_newbcast:12 row_mask:0xf bank_mask:0xf
  v_and_b32_dpp v33, v68, v3 row_newbcast:12 row_mask:0xf bank_mask:0xf
  v_and_b32_dpp v34, v68, v4 row_newbcast:12 row_mask:0xf bank_mask:0xf
  v_and_b32_dpp v35, v68, v5 row_newbcast:12 row_mask:0xf bank_mask:0xf
  v_mfma_f32_16x16x32_bf16 v[36:39], v[152:155], v[28:31], v[36:39]
  buffer_load_dwordx4 v[152:155], v9, s[28:31], s72 offen nt
  s_addk_i32 s72, 0x1000
  s_cmp_ge_u32 s72, s14
  s_cselect_b32 s72, 0, s72
  v_and_b32_dpp v28, v69, v2 row_newbcast:0 row_mask:0xf bank_mask:0xf
  v_and_b32_dpp v29, v69, v3 row_newbcast:0 row_mask:0xf bank_mask:0xf
  v_and_b32_dpp v30, v69, v4 row_newbcast:0 row_mask:0xf bank_mask:0xf
  v_and_b32_dpp v31, v69, v5 row_newbcast:0 row_mask:0xf bank_mask:0xf
  v_mfma_f32_16x16x32_bf16 v[36:39], v[156:159], v[32:35], v[36:39]
  buffer_load_dwordx4 v[156:159], v9, s[28:31], s72 offen nt
  s_addk_i32 s72, 0x1000
  s_cmp_ge_u32 s72, s14
  s_cselect_b32 s72, 0, s72
  v_and_b32_dpp v32, v69, v2 row_newbcast:4 row_mask:0xf bank_mask:0xf
  v_and_b32_dpp v33, v69, v3 row_newbcast:4 row_mask:0xf bank_mask:0xf
  v_and_b32_dpp v34, v69, v4 row_newbcast:4 row_mask:0xf bank_mask:0xf
  v_and_b32_dpp v35, v69, v5 row_newbcast:4 row_mask:0xf bank_mask:0xf
  v_mfma_f32_16x16x32_bf16 v[36:39], v[160:163], v[28:31], v[36:39]
  buffer_load_dwordx4 v[160:163], v9, s[28:31], s72 offen nt
  s_addk_i32 s72, 0x1000
  s_cmp_ge_u32 s72, s14
  s_cselect_b32 s72, 0, s72
  v_and_b32_dpp v28, v69, v2 row_newbcast:8 row_mask:0xf bank_mask:0xf
  v_and_b32_dpp v29, v69, v3 row_newbcast:8 row_mask:0xf bank_mask:0xf
  v_and_b32_dpp v30, v69, v4 row_newbcast:8 row_mask:0xf bank_mask:0xf
  v_and_b32_dpp v31, v69, v5 row_newbcast:8 row_mask:0xf bank_mask:0xf
  v_mfma_f32_16x16x32_bf16 v[36:39], v[164:167], v[32:35], v[36:39]
  buffer_load_dwordx4 v[164:167], v9, s[28:31], s72 offen nt
  s_addk_i32 s72, 0x1000
  s_cmp_ge_u32 s72, s14
  s_cselect_b32 s72, 0, s72
  v_and_b32_dpp v32, v69, v2 row_newbcast:12 row_mask:0xf bank_mask:0xf
  v_and_b32_dpp v33, v69, v3 row_newbcast:12 row_mask:0xf bank_mask:0xf
  v_and_b32_dpp v34, v69, v4 row_newbcast:12 row_mask:0xf bank_mask:0xf
  v_and_b32_dpp v35, v69, v5 row_newbcast:12 row_mask:0xf bank_mask:0xf
  v_mfma_f32_16x16x32_bf16 v[36:39], v[168:171], v[28:31], v[36:39]
  buffer_load_dwordx4 v[168:171], v9, s[28:31], s72 offen nt
  s_addk_i32 s72, 0x1000
  s_cmp_ge_u32 s72, s14
  s_cselect_b32 s72, 0, s72
  v_and_b32_dpp v28, v70, v2 row_newbcast:0 row_mask:0xf bank_mask:0xf
  v_and_b32_dpp v29, v70, v3 row_newbcast:0 row_mask:0xf bank_mask:0xf
  v_and_b32_dpp v30, v70, v4 row_newbcast:0 row_mask:0xf bank_mask:0xf
  v_and_b32_dpp v31, v70, v5 row_newbcast:0 row_mask:0xf bank_mask:0xf
  v_mfma_f32_16x16x32_bf16 v[36:39], v[172:175], v[32:35], v[36:39]
  buffer_load_dwordx4 v[172:175], v9, s[28:31], s72 offen nt
  s_addk_i32 s72, 0x1000
  s_cmp_ge_u32 s72, s14
  s_cselect_b32 s72, 0, s72
  v_and_b32_dpp v32, v70, v2 row_newbcast:4 row_mask:0xf bank_mask:0xf
  v_and_b32_dpp v33, v70, v3 row_newbcast:4 row_mask:0xf bank_mask:0xf
  v_and_b32_dpp v34, v70, v4 row_newbcast:4 row_mask:0xf bank_mask:0xf
  v_and_b32_dpp v35, v70, v5 row_newbcast:4 row_mask:0xf bank_mask:0xf
  s_waitcnt vmcnt(32)
  v_mfma_f32_16x16x32_bf16 v[36:39], v[176:179], v[28:31], v[36:39]
  buffer_load_dwordx4 v[176:179], v9, s[28:31], s72 offen nt
  s_addk_i32 s72, 0x1000
  s_cmp_ge_u32 s72, s14
  s_cselect_b32 s72, 0, s72
  v_and_b32_dpp v28, v70, v2 row_newbcast:8 row_mask:0xf bank_mask:0xf
  v_and_b32_dpp v29, v70, v3 row_newbcast:8 row_mask:0xf bank_mask:0xf
  v_and_b32_dpp v30, v70, v4 row_newbcast:8 row_mask:0xf bank_mask:0xf
  v_and_b32_dpp v31, v70, v5 row_newbcast:8 row_mask:0xf bank_mask:0xf
  s_waitcnt vmcnt(32)
  v_mfma_f32_16x16x32_bf16 v[36:39], v[180:183], v[32:35], v[36:39]
  buffer_load_dwordx4 v[180:183], v9, s[28:31], s72 offen nt
  s_addk_i32 s72, 0x1000
  s_cmp_ge_u32 s72, s14
  s_cselect_b32 s72, 0, s72
  v_and_b32_dpp v32, v70, v2 row_newbcast:12 row_mask:0xf bank_mask:0xf
  v_and_b32_dpp v33, v70, v3 row_newbcast:12 row_mask:0xf bank_mask:0xf
  v_and_b32_dpp v34, v70, v4 row_newbcast:12 row_mask:0xf bank_mask:0xf
  v_and_b32_dpp v35, v70, v5 row_newbcast:12 row_mask:0xf bank_mask:0xf
  s_waitcnt vmcnt(32)
  v_mfma_f32_16x16x32_bf16 v[36:39], v[184:187], v[28:31], v[36:39]
  buffer_load_dwordx4 v[184:187], v9, s[28:31], s72 offen nt
  s_addk_i32 s72, 0x1000
  s_cmp_ge_u32 s72, s14
  s_cselect_b32 s72, 0, s72
  v_and_b32_dpp v28, v71, v2 row_newbcast:0 row_mask:0xf bank_mask:0xf
  v_and_b32_dpp v29, v71, v3 row_newbcast:0 row_mask:0xf bank_mask:0xf
  v_and_b32_dpp v30, v71, v4 row_newbcast:0 row_mask:0xf bank_mask:0xf
  v_and_b32_dpp v31, v71, v5 row_newbcast:0 row_mask:0xf bank_mask:0xf
  s_waitcnt vmcnt(32)
  v_mfma_f32_16x16x32_bf16 v[36:39], v[188:191], v[32:35], v[36:39]
  buffer_load_dwordx4 v[188:191], v9, s[28:31], s72 offen nt
  s_addk_i32 s72, 0x1000
  s_cmp_ge_u32 s72, s14
  s_cselect_b32 s72, 0, s72
  v_and_b32_dpp v32, v71, v2 row_newbcast:4 row_mask:0xf bank_mask:0xf
  v_and_b32_dpp v33, v71, v3 row_newbcast:4 row_mask:0xf bank_mask:0xf
  v_and_b32_dpp v34, v71, v4 row_newbcast:4 row_mask:0xf bank_mask:0xf
  v_and_b32_dpp v35, v71, v5 row_newbcast:4 row_mask:0xf bank_mask:0xf
  s_waitcnt vmcnt(32)
  v_mfma_f32_16x16x32_bf16 v[36:39], v[192:195], v[28:31], v[36:39]
  buffer_load_dwordx4 v[192:195], v9, s[28:31], s72 offen nt
  s_addk_i32 s72, 0x1000
  s_cmp_ge_u32 s72, s14
  s_cselect_b32 s72, 0, s72
  v_and_b32_dpp v28, v71, v2 row_newbcast:8 row_mask:0xf bank_mask:0xf
  v_and_b32_dpp v29, v71, v3 row_newbcast:8 row_mask:0xf bank_mask:0xf
  v_and_b32_dpp v30, v71, v4 row_newbcast:8 row_mask:0xf bank_mask:0xf
  v_and_b32_dpp v31, v71, v5 row_newbcast:8 row_mask:0xf bank_mask:0xf
  s_waitcnt vmcnt(32)
  v_mfma_f32_16x16x32_bf16 v[36:39], v[196:199], v[32:35], v[36:39]
  buffer_load_dwordx4 v[196:199], v9, s[28:31], s72 offen nt
  s_addk_i32 s72, 0x1000
  s_cmp_ge_u32 s72, s14
  s_cselect_b32 s72, 0, s72
  v_and_b32_dpp v32, v71, v2 row_newbcast:12 row_mask:0xf bank_mask:0xf
  v_and_b32_dpp v33, v71, v3 row_newbcast:12 row_mask:0xf bank_mask:0xf
  v_and_b32_dpp v34, v71, v4 row_newbcast:12 row_mask:0xf bank_mask:0xf
  v_and_b32_dpp v35, v71, v5 row_newbcast:12 row_mask:0xf bank_mask:0xf
  s_waitcnt vmcnt(32)
  v_mfma_f32_16x16x32_bf16 v[36:39], v[200:203], v[28:31], v[36:39]
  buffer_load_dwordx4 v[200:203], v9, s[28:31], s72 offen nt
  s_addk_i32 s72, 0x1000
  s_cmp_ge_u32 s72, s14
  s_cselect_b32 s72, 0, s72
  v_and_b32_dpp v28, v72, v2 row_newbcast:0 row_mask:0xf bank_mask:0xf
  v_and_b32_dpp v29, v72, v3 row_newbcast:0 row_mask:0xf bank_mask:0xf
  v_and_b32_dpp v30, v72, v4 row_newbcast:0 row_mask:0xf bank_mask:0xf
  v_and_b32_dpp v31, v72, v5 row_newbcast:0 row_mask:0xf bank_mask:0xf
  s_waitcnt vmcnt(32)
  v_mfma_f32_16x16x32_bf16 v[36:39], v[204:207], v[32:35], v[36:39]
  buffer_load_dwordx4 v[204:207], v9, s[28:31], s72 offen nt
  s_addk_i32 s72, 0x1000
  s_cmp_ge_u32 s72, s14
  s_cselect_b32 s72, 0, s72
  v_and_b32_dpp v32, v72, v2 row_newbcast:4 row_mask:0xf bank_mask:0xf
  v_and_b32_dpp v33, v72, v3 row_newbcast:4 row_mask:0xf bank_mask:0xf
  v_and_b32_dpp v34, v72, v4 row_newbcast:4 row_mask:0xf bank_mask:0xf
  v_and_b32_dpp v35, v72, v5 row_newbcast:4 row_mask:0xf bank_mask:0xf
  s_waitcnt vmcnt(32)
  v_mfma_f32_16x16x32_bf16 v[36:39], v[208:211], v[28:31], v[36:39]
  buffer_load_dwordx4 v[208:211], v9, s[28:31], s72 offen nt
  s_addk_i32 s72, 0x1000
  s_cmp_ge_u32 s72, s14
  s_cselect_b32 s72, 0, s72
  v_and_b32_dpp v28, v72, v2 row_newbcast:8 row_mask:0xf bank_mask:0xf
  v_and_b32_dpp v29, v72, v3 row_newbcast:8 row_mask:0xf bank_mask:0xf
  v_and_b32_dpp v30, v72, v4 row_newbcast:8 row_mask:0xf bank_mask:0xf
  v_and_b32_dpp v31, v72, v5 row_newbcast:8 row_mask:0xf bank_mask:0xf
  s_waitcnt vmcnt(32)
  v_mfma_f32_16x16x32_bf16 v[36:39], v[212:215], v[32:35], v[36:39]
  buffer_load_dwordx4 v[212:215], v9, s[28:31], s72 offen nt
  s_addk_i32 s72, 0x1000
  s_cmp_ge_u32 s72, s14
  s_cselect_b32 s72, 0, s72
  v_and_b32_dpp v32, v72, v2 row_newbcast:12 row_mask:0xf bank_mask:0xf
  v_and_b32_dpp v33, v72, v3 row_newbcast:12 row_mask:0xf bank_mask:0xf
  v_and_b32_dpp v34, v72, v4 row_newbcast:12 row_mask:0xf bank_mask:0xf
  v_and_b32_dpp v35, v72, v5 row_newbcast:12 row_mask:0xf bank_mask:0xf
  s_waitcnt vmcnt(32)
  v_mfma_f32_16x16x32_bf16 v[36:39], v[216:219], v[28:31], v[36:39]
  buffer_load_dwordx4 v[216:219], v9, s[28:31], s72 offen nt
  s_addk_i32 s72, 0x1000
  s_cmp_ge_u32 s72, s14
  s_cselect_b32 s72, 0, s72
  v_and_b32_dpp v28, v73, v2 row_newbcast:0 row_mask:0xf bank_mask:0xf
  v_and_b32_dpp v29, v73, v3 row_newbcast:0 row_mask:0xf bank_mask:0xf
  v_and_b32_dpp v30, v73, v4 row_newbcast:0 row_mask:0xf bank_mask:0xf
  v_and_b32_dpp v31, v73, v5 row_newbcast:0 row_mask:0xf bank_mask:0xf
  s_waitcnt vmcnt(32)
  v_mfma_f32_16x16x32_bf16 v[36:39], v[220:223], v[32:35], v[36:39]
  buffer_load_dwordx4 v[220:223], v9, s[28:31], s72 offen nt
  s_addk_i32 s72, 0x1000
  s_cmp_ge_u32 s72, s14
  s_cselect_b32 s72, 0, s72
  v_and_b32_dpp v32, v73, v2 row_newbcast:4 row_mask:0xf bank_mask:0xf
  v_and_b32_dpp v33, v73, v3 row_newbcast:4 row_mask:0xf bank_mask:0xf
  v_and_b32_dpp v34, v73, v4 row_newbcast:4 row_mask:0xf bank_mask:0xf
  v_and_b32_dpp v35, v73, v5 row_newbcast:4 row_mask:0xf bank_mask:0xf
  s_waitcnt vmcnt(32)
  v_mfma_f32_16x16x32_bf16 v[36:39], v[224:227], v[28:31], v[36:39]
  buffer_load_dwordx4 v[224:227], v9, s[28:31], s72 offen nt
  s_addk_i32 s72, 0x1000
  s_cmp_ge_u32 s72, s14
  s_cselect_b32 s72, 0, s72
  v_and_b32_dpp v28, v73, v2 row_newbcast:8 row_mask:0xf bank_mask:0xf
  v_and_b32_dpp v29, v73, v3 row_newbcast:8 row_mask:0xf bank_mask:0xf
  v_and_b32_dpp v30, v73, v4 row_newbcast:8 row_mask:0xf bank_mask:0xf
  v_and_b32_dpp v31, v73, v5 row_newbcast:8 row_mask:0xf bank_mask:0xf
  s_waitcnt vmcnt(32)
  v_mfma_f32_16x16x32_bf16 v[36:39], v[228:231], v[32:35], v[36:39]
  buffer_load_dwordx4 v[228:231], v9, s[28:31], s72 offen nt
  s_addk_i32 s72, 0x1000
  s_cmp_ge_u32 s72, s14
  s_cselect_b32 s72, 0, s72
  v_and_b32_dpp v32, v73, v2 row_newbcast:12 row_mask:0xf bank_mask:0xf
  v_and_b32_dpp v33, v73, v3 row_newbcast:12 row_mask:0xf bank_mask:0xf
  v_and_b32_dpp v34, v73, v4 row_newbcast:12 row_mask:0xf bank_mask:0xf
  v_and_b32_dpp v35, v73, v5 row_newbcast:12 row_mask:0xf bank_mask:0xf
  s_waitcnt vmcnt(32)
  v_mfma_f32_16x16x32_bf16 v[36:39], v[232:235], v[28:31], v[36:39]
  buffer_load_dwordx4 v[232:235], v9, s[28:31], s72 offen nt
  s_addk_i32 s72, 0x1000
  s_cmp_ge_u32 s72, s14
  s_cselect_b32 s72, 0, s72
  v_and_b32_dpp v28, v74, v2 row_newbcast:0 row_mask:0xf bank_mask:0xf
  v_and_b32_dpp v29, v74, v3 row_newbcast:0 row_mask:0xf bank_mask:0xf
  v_and_b32_dpp v30, v74, v4 row_newbcast:0 row_mask:0xf bank_mask:0xf
  v_and_b32_dpp v31, v74, v5 row_newbcast:0 row_mask:0xf bank_mask:0xf
  s_waitcnt vmcnt(32)
  v_mfma_f32_16x16x32_bf16 v[36:39], v[236:239], v[32:35], v[36:39]
  buffer_load_dwordx4 v[236:239], v9, s[28:31], s72 offen nt
  s_addk_i32 s72, 0x1000
  s_cmp_ge_u32 s72, s14
  s_cselect_b32 s72, 0, s72
  v_and_b32_dpp v32, v74, v2 row_newbcast:4 row_mask:0xf bank_mask:0xf
  v_and_b32_dpp v33, v74, v3 row_newbcast:4 row_mask:0xf bank_mask:0xf
  v_and_b32_dpp v34, v74, v4 row_newbcast:4 row_mask:0xf bank_mask:0xf
  v_and_b32_dpp v35, v74, v5 row_newbcast:4 row_mask:0xf bank_mask:0xf
  s_waitcnt vmcnt(32)
  v_mfma_f32_16x16x32_bf16 v[36:39], v[240:243], v[28:31], v[36:39]
  buffer_load_dwordx4 v[240:243], v9, s[28:31], s72 offen nt
  s_addk_i32 s72, 0x1000
  s_cmp_ge_u32 s72, s14
  s_cselect_b32 s72, 0, s72
  v_and_b32_dpp v28, v74, v2 row_newbcast:8 row_mask:0xf bank_mask:0xf
  v_and_b32_dpp v29, v74, v3 row_newbcast:8 row_mask:0xf bank_mask:0xf
  v_and_b32_dpp v30, v74, v4 row_newbcast:8 row_mask:0xf bank_mask:0xf
  v_and_b32_dpp v31, v74, v5 row_newbcast:8 row_mask:0xf bank_mask:0xf
  s_waitcnt vmcnt(32)
  v_mfma_f32_16x16x32_bf16 v[36:39], v[244:247], v[32:35], v[36:39]
  buffer_load_dwordx4 v[244:247], v9, s[28:31], s72 offen nt
  s_addk_i32 s72, 0x1000
  s_cmp_ge_u32 s72, s14
  s_cselect_b32 s72, 0, s72
  v_and_b32_dpp v32, v74, v2 row_newbcast:12 row_mask:0xf bank_mask:0xf
  v_and_b32_dpp v33, v74, v3 row_newbcast:12 row_mask:0xf bank_mask:0xf
  v_and_b32_dpp v34, v74, v4 row_newbcast:12 row_mask:0xf bank_mask:0xf
  v_and_b32_dpp v35, v74, v5 row_newbcast:12 row_mask:0xf bank_mask:0xf
  s_waitcnt vmcnt(32)
  v_mfma_f32_16x16x32_bf16 v[36:39], v[248:251], v[28:31], v[36:39]
  buffer_load_dwordx4 v[248:251], v9, s[28:31], s72 offen nt
  s_addk_i32 s72, 0x1000
  s_cmp_ge_u32 s72, s14
  s_cselect_b32 s72, 0, s72
  v_and_b32_dpp v28, v75, v2 row_newbcast:0 row_mask:0xf bank_mask:0xf
  v_and_b32_dpp v29, v75, v3 row_newbcast:0 row_mask:0xf bank_mask:0xf
  v_and_b32_dpp v30, v75, v4 row_newbcast:0 row_mask:0xf bank_mask:0xf
  v_and_b32_dpp v31, v75, v5 row_newbcast:0 row_mask:0xf bank_mask:0xf
  s_waitcnt vmcnt(32)
  v_mfma_f32_16x16x32_bf16 v[36:39], v[252:255], v[32:35], v[36:39]
  buffer_load_dwordx4 v[252:255], v9, s[28:31], s72 offen nt
  s_addk_i32 s72, 0x1000
  s_cmp_ge_u32 s72, s14
  s_cselect_b32 s72, 0, s72
  v_and_b32_dpp v32, v75, v2 row_newbcast:4 row_mask:0xf bank_mask:0xf
  v_and_b32_dpp v33, v75, v3 row_newbcast:4 row_mask:0xf bank_mask:0xf
  v_and_b32_dpp v34, v75, v4 row_newbcast:4 row_mask:0xf bank_mask:0xf
  v_and_b32_dpp v35, v75, v5 row_newbcast:4 row_mask:0xf bank_mask:0xf
  s_waitcnt vmcnt(32)
  v_mfma_f32_16x16x32_bf16 v[36:39], v[128:131], v[28:31], v[36:39]
  buffer_load_dwordx4 v[128:131], v9, s[28:31], s72 offen nt
  s_addk_i32 s72, 0x1000
  s_cmp_ge_u32 s72, s14
  s_cselect_b32 s72, 0, s72
  v_and_b32_dpp v28, v75, v2 row_newbcast:8 row_mask:0xf bank_mask:0xf
  v_and_b32_dpp v29, v75, v3 row_newbcast:8 row_mask:0xf bank_mask:0xf
  v_and_b32_dpp v30, v75, v4 row_newbcast:8 row_mask:0xf bank_mask:0xf
  v_and_b32_dpp v31, v75, v5 row_newbcast:8 row_mask:0xf bank_mask:0xf
  s_waitcnt vmcnt(32)
  v_mfma_f32_16x16x32_bf16 v[36:39], v[132:135], v[32:35], v[36:39]
  buffer_load_dwordx4 v[132:135], v9, s[28:31], s72 offen nt
  s_addk_i32 s72, 0x1000
  s_cmp_ge_u32 s72, s14
  s_cselect_b32 s72, 0, s72
  v_and_b32_dpp v32, v75, v2 row_newbcast:12 row_mask:0xf bank_mask:0xf
  v_and_b32_dpp v33, v75, v3 row_newbcast:12 row_mask:0xf bank_mask:0xf
  v_and_b32_dpp v34, v75, v4 row_newbcast:12 row_mask:0xf bank_mask:0xf
  v_and_b32_dpp v35, v75, v5 row_newbcast:12 row_mask:0xf bank_mask:0xf
  s_waitcnt vmcnt(32)
  v_mfma_f32_16x16x32_bf16 v[36:39], v[136:139], v[28:31], v[36:39]
  buffer_load_dwordx4 v[136:139], v9, s[28:31], s72 offen nt
  s_addk_i32 s72, 0x1000
  s_cmp_ge_u32 s72, s14
  s_cselect_b32 s72, 0, s72
  v_and_b32_dpp v28, v76, v2 row_newbcast:0 row_mask:0xf bank_mask:0xf
  v_and_b32_dpp v29, v76, v3 row_newbcast:0 row_mask:0xf bank_mask:0xf
  v_and_b32_dpp v30, v76, v4 row_newbcast:0 row_mask:0xf bank_mask:0xf
  v_and_b32_dpp v31, v76, v5 row_newbcast:0 row_mask:0xf bank_mask:0xf
  s_waitcnt vmcnt(32)
  v_mfma_f32_16x16x32_bf16 v[36:39], v[140:143], v[32:35], v[36:39]
  buffer_load_dwordx4 v[140:143], v9, s[28:31], s72 offen nt
  s_addk_i32 s72, 0x1000
  s_cmp_ge_u32 s72, s14
  s_cselect_b32 s72, 0, s72
  v_and_b32_dpp v32, v76, v2 row_newbcast:4 row_mask:0xf bank_mask:0xf
  v_and_b32_dpp v33, v76, v3 row_newbcast:4 row_mask:0xf bank_mask:0xf
  v_and_b32_dpp v34, v76, v4 row_newbcast:4 row_mask:0xf bank_mask:0xf
  v_and_b32_dpp v35, v76, v5 row_newbcast:4 row_mask:0xf bank_mask:0xf
  s_waitcnt vmcnt(31)
  v_mfma_f32_16x16x32_bf16 v[36:39], v[144:147], v[28:31], v[36:39]
  buffer_load_dwordx4 v[144:147], v9, s[28:31], s72 offen nt
  s_addk_i32 s72, 0x1000
  s_cmp_ge_u32 s72, s14
  s_cselect_b32 s72, 0, s72
  v_and_b32_dpp v28, v76, v2 row_newbcast:8 row_mask:0xf bank_mask:0xf
  v_and_b32_dpp v29, v76, v3 row_newbcast:8 row_mask:0xf bank_mask:0xf
  v_and_b32_dpp v30, v76, v4 row_newbcast:8 row_mask:0xf bank_mask:0xf
  v_and_b32_dpp v31, v76, v5 row_newbcast:8 row_mask:0xf bank_mask:0xf
  s_waitcnt vmcnt(31)
  v_mfma_f32_16x16x32_bf16 v[36:39], v[148:151], v[32:35], v[36:39]
  buffer_load_dwordx4 v[148:151], v9, s[28:31], s72 offen nt
  s_addk_i32 s72, 0x1000
  s_cmp_ge_u32 s72, s14
  s_cselect_b32 s72, 0, s72
  v_and_b32_dpp v32, v76, v2 row_newbcast:12 row_mask:0xf bank_mask:0xf
  v_and_b32_dpp v33, v76, v3 row_newbcast:12 row_mask:0xf bank_mask:0xf
  v_and_b32_dpp v34, v76, v4 row_newbcast:12 row_mask:0xf bank_mask:0xf
  v_and_b32_dpp v35, v76, v5 row_newbcast:12 row_mask:0xf bank_mask:0xf
  s_waitcnt vmcnt(31)
  v_mfma_f32_16x16x32_bf16 v[36:39], v[152:155], v[28:31], v[36:39]
  buffer_load_dwordx4 v[152:155], v9, s[28:31], s72 offen nt
  s_addk_i32 s72, 0x1000
  s_cmp_ge_u32 s72, s14
  s_cselect_b32 s72, 0, s72
  v_and_b32_dpp v28, v77, v2 row_newbcast:0 row_mask:0xf bank_mask:0xf
  v_and_b32_dpp v29, v77, v3 row_newbcast:0 row_mask:0xf bank_mask:0xf
  v_and_b32_dpp v30, v77, v4 row_newbcast:0 row_mask:0xf bank_mask:0xf
  v_and_b32_dpp v31, v77, v5 row_newbcast:0 row_mask:0xf bank_mask:0xf
  s_waitcnt vmcnt(31)
  v_mfma_f32_16x16x32_bf16 v[36:39], v[156:159], v[32:35], v[36:39]
  buffer_load_dwordx4 v[156:159], v9, s[28:31], s72 offen nt
  s_addk_i32 s72, 0x1000
  s_cmp_ge_u32 s72, s14
  s_cselect_b32 s72, 0, s72
  v_and_b32_dpp v32, v77, v2 row_newbcast:4 row_mask:0xf bank_mask:0xf
  v_and_b32_dpp v33, v77, v3 row_newbcast:4 row_mask:0xf bank_mask:0xf
  v_and_b32_dpp v34, v77, v4 row_newbcast:4 row_mask:0xf bank_mask:0xf
  v_and_b32_dpp v35, v77, v5 row_newbcast:4 row_mask:0xf bank_mask:0xf
  s_waitcnt vmcnt(31)
  v_mfma_f32_16x16x32_bf16 v[36:39], v[160:163], v[28:31], v[36:39]
  buffer_load_dwordx4 v[160:163], v9, s[28:31], s72 offen nt
  s_addk_i32 s72, 0x1000
  s_cmp_ge_u32 s72, s14
  s_cselect_b32 s72, 0, s72
  v_and_b32_dpp v28, v77, v2 row_newbcast:8 row_mask:0xf bank_mask:0xf
  v_and_b32_dpp v29, v77, v3 row_newbcast:8 row_mask:0xf bank_mask:0xf
  v_and_b32_dpp v30, v77, v4 row_newbcast:8 row_mask:0xf bank_mask:0xf
  v_and_b32_dpp v31, v77, v5 row_newbcast:8 row_mask:0xf bank_mask:0xf
  s_waitcnt vmcnt(31)
  v_mfma_f32_16x16x32_bf16 v[36:39], v[164:167], v[32:35], v[36:39]
  buffer_load_dwordx4 v[164:167], v9, s[28:31], s72 offen nt
  s_addk_i32 s72, 0x1000
  s_cmp_ge_u32 s72, s14
  s_cselect_b32 s72, 0, s72
  v_and_b32_dpp v32, v77, v2 row_newbcast:12 row_mask:0xf bank_mask:0xf
  v_and_b32_dpp v33, v77, v3 row_newbcast:12 row_mask:0xf bank_mask:0xf
  v_and_b32_dpp v34, v77, v4 row_newbcast:12 row_mask:0xf bank_mask:0xf
  v_and_b32_dpp v35, v77, v5 row_newbcast:12 row_mask:0xf bank_mask:0xf
  s_waitcnt vmcnt(31)
  v_mfma_f32_16x16x32_bf16 v[36:39], v[168:171], v[28:31], v[36:39]
  buffer_load_dwordx4 v[168:171], v9, s[28:31], s72 offen nt
  s_addk_i32 s72, 0x1000
  s_cmp_ge_u32 s72, s14
  s_cselect_b32 s72, 0, s72
  v_and_b32_dpp v28, v78, v2 row_newbcast:0 row_mask:0xf bank_mask:0xf
  v_and_b32_dpp v29, v78, v3 row_newbcast:0 row_mask:0xf bank_mask:0xf
  v_and_b32_dpp v30, v78, v4 row_newbcast:0 row_mask:0xf bank_mask:0xf
  v_and_b32_dpp v31, v78, v5 row_newbcast:0 row_mask:0xf bank_mask:0xf
  s_waitcnt vmcnt(31)
  v_mfma_f32_16x16x32_bf16 v[36:39], v[172:175], v[32:35], v[36:39]
  buffer_load_dwordx4 v[172:175], v9, s[28:31], s72 offen nt
  s_addk_i32 s72, 0x1000
  s_cmp_ge_u32 s72, s14
  s_cselect_b32 s72, 0, s72
  v_and_b32_dpp v32, v78, v2 row_newbcast:4 row_mask:0xf bank_mask:0xf
  v_and_b32_dpp v33, v78, v3 row_newbcast:4 row_mask:0xf bank_mask:0xf
  v_and_b32_dpp v34, v78, v4 row_newbcast:4 row_mask:0xf bank_mask:0xf
  v_and_b32_dpp v35, v78, v5 row_newbcast:4 row_mask:0xf bank_mask:0xf
  s_waitcnt vmcnt(31)
  v_mfma_f32_16x16x32_bf16 v[36:39], v[176:179], v[28:31], v[36:39]
  buffer_load_dwordx4 v[176:179], v9, s[28:31], s72 offen nt
  s_addk_i32 s72, 0x1000
  s_cmp_ge_u32 s72, s14
  s_cselect_b32 s72, 0, s72
  v_and_b32_dpp v28, v78, v2 row_newbcast:8 row_mask:0xf bank_mask:0xf
  v_and_b32_dpp v29, v78, v3 row_newbcast:8 row_mask:0xf bank_mask:0xf
  v_and_b32_dpp v30, v78, v4 row_newbcast:8 row_mask:0xf bank_mask:0xf
  v_and_b32_dpp v31, v78, v5 row_newbcast:8 row_mask:0xf bank_mask:0xf
  s_waitcnt vmcnt(31)
  v_mfma_f32_16x16x32_bf16 v[36:39], v[180:183], v[32:35], v[36:39]
  buffer_load_dwordx4 v[180:183], v9, s[28:31], s72 offen nt
  s_addk_i32 s72, 0x1000
  s_cmp_ge_u32 s72, s14
  s_cselect_b32 s72, 0, s72
  v_and_b32_dpp v32, v78, v2 row_newbcast:12 row_mask:0xf bank_mask:0xf
  v_and_b32_dpp v33, v78, v3 row_newbcast:12 row_mask:0xf bank_mask:0xf
  v_and_b32_dpp v34, v78, v4 row_newbcast:12 row_mask:0xf bank_mask:0xf
  v_and_b32_dpp v35, v78, v5 row_newbcast:12 row_mask:0xf bank_mask:0xf
  s_waitcnt vmcnt(31)
  v_mfma_f32_16x16x32_bf16 v[36:39], v[184:187], v[28:31], v[36:39]
  buffer_load_dwordx4 v[184:187], v9, s[28:31], s72 offen nt
  s_addk_i32 s72, 0x1000
  s_cmp_ge_u32 s72, s14
  s_cselect_b32 s72, 0, s72
  v_and_b32_dpp v28, v79, v2 row_newbcast:0 row_mask:0xf bank_mask:0xf
  v_and_b32_dpp v29, v79, v3 row_newbcast:0 row_mask:0xf bank_mask:0xf
  v_and_b32_dpp v30, v79, v4 row_newbcast:0 row_mask:0xf bank_mask:0xf
  v_and_b32_dpp v31, v79, v5 row_newbcast:0 row_mask:0xf bank_mask:0xf
  s_waitcnt vmcnt(31)
  v_mfma_f32_16x16x32_bf16 v[36:39], v[188:191], v[32:35], v[36:39]
  buffer_load_dwordx4 v[188:191], v9, s[28:31], s72 offen nt
  s_addk_i32 s72, 0x1000
  s_cmp_ge_u32 s72, s14
  s_cselect_b32 s72, 0, s72
  v_and_b32_dpp v32, v79, v2 row_newbcast:4 row_mask:0xf bank_mask:0xf
  v_and_b32_dpp v33, v79, v3 row_newbcast:4 row_mask:0xf bank_mask:0xf
  v_and_b32_dpp v34, v79, v4 row_newbcast:4 row_mask:0xf bank_mask:0xf
  v_and_b32_dpp v35, v79, v5 row_newbcast:4 row_mask:0xf bank_mask:0xf
  s_waitcnt vmcnt(31)
  v_mfma_f32_16x16x32_bf16 v[36:39], v[192:195], v[28:31], v[36:39]
  buffer_load_dwordx4 v[192:195], v9, s[28:31], s72 offen nt
  s_addk_i32 s72, 0x1000
  s_cmp_ge_u32 s72, s14
  s_cselect_b32 s72, 0, s72
  v_and_b32_dpp v28, v79, v2 row_newbcast:8 row_mask:0xf bank_mask:0xf
  v_and_b32_dpp v29, v79, v3 row_newbcast:8 row_mask:0xf bank_mask:0xf
  v_and_b32_dpp v30, v79, v4 row_newbcast:8 row_mask:0xf bank_mask:0xf
  v_and_b32_dpp v31, v79, v5 row_newbcast:8 row_mask:0xf bank_mask:0xf
  s_waitcnt vmcnt(31)
  v_mfma_f32_16x16x32_bf16 v[36:39], v[196:199], v[32:35], v[36:39]
  buffer_load_dwordx4 v[196:199], v9, s[28:31], s72 offen nt
  s_addk_i32 s72, 0x1000
  s_cmp_ge_u32 s72, s14
  s_cselect_b32 s72, 0, s72
  v_and_b32_dpp v32, v79, v2 row_newbcast:12 row_mask:0xf bank_mask:0xf
  v_and_b32_dpp v33, v79, v3 row_newbcast:12 row_mask:0xf bank_mask:0xf
  v_and_b32_dpp v34, v79, v4 row_newbcast:12 row_mask:0xf bank_mask:0xf
  v_and_b32_dpp v35, v79, v5 row_newbcast:12 row_mask:0xf bank_mask:0xf
  s_waitcnt vmcnt(31)
  v_mfma_f32_16x16x32_bf16 v[36:39], v[200:203], v[28:31], v[36:39]
  buffer_load_dwordx4 v[200:203], v9, s[28:31], s72 offen nt
  s_addk_i32 s72, 0x1000
  s_cmp_ge_u32 s72, s14
  s_cselect_b32 s72, 0, s72
  v_and_b32_dpp v28, v80, v2 row_newbcast:0 row_mask:0xf bank_mask:0xf
  v_and_b32_dpp v29, v80, v3 row_newbcast:0 row_mask:0xf bank_mask:0xf
  v_and_b32_dpp v30, v80, v4 row_newbcast:0 row_mask:0xf bank_mask:0xf
  v_and_b32_dpp v31, v80, v5 row_newbcast:0 row_mask:0xf bank_mask:0xf
  s_waitcnt vmcnt(31)
  v_mfma_f32_16x16x32_bf16 v[36:39], v[204:207], v[32:35], v[36:39]
  buffer_load_dwordx4 v[204:207], v9, s[28:31], s72 offen nt
  s_addk_i32 s72, 0x1000
  s_cmp_ge_u32 s72, s14
  s_cselect_b32 s72, 0, s72
  v_and_b32_dpp v32, v80, v2 row_newbcast:4 row_mask:0xf bank_mask:0xf
  v_and_b32_dpp v33, v80, v3 row_newbcast:4 row_mask:0xf bank_mask:0xf
  v_and_b32_dpp v34, v80, v4 row_newbcast:4 row_mask:0xf bank_mask:0xf
  v_and_b32_dpp v35, v80, v5 row_newbcast:4 row_mask:0xf bank_mask:0xf
  s_waitcnt vmcnt(31)
  v_mfma_f32_16x16x32_bf16 v[36:39], v[208:211], v[28:31], v[36:39]
  buffer_load_dwordx4 v[208:211], v9, s[28:31], s72 offen nt
  s_addk_i32 s72, 0x1000
  s_cmp_ge_u32 s72, s14
  s_cselect_b32 s72, 0, s72
  v_and_b32_dpp v28, v80, v2 row_newbcast:8 row_mask:0xf bank_mask:0xf
  v_and_b32_dpp v29, v80, v3 row_newbcast:8 row_mask:0xf bank_mask:0xf
  v_and_b32_dpp v30, v80, v4 row_newbcast:8 row_mask:0xf bank_mask:0xf
  v_and_b32_dpp v31, v80, v5 row_newbcast:8 row_mask:0xf bank_mask:0xf
  s_waitcnt vmcnt(31)
  v_mfma_f32_16x16x32_bf16 v[36:39], v[212:215], v[32:35], v[36:39]
  buffer_load_dwordx4 v[212:215], v9, s[28:31], s72 offen nt
  s_addk_i32 s72, 0x1000
  s_cmp_ge_u32 s72, s14
  s_cselect_b32 s72, 0, s72
  v_and_b32_dpp v32, v80, v2 row_newbcast:12 row_mask:0xf bank_mask:0xf
  v_and_b32_dpp v33, v80, v3 row_newbcast:12 row_mask:0xf bank_mask:0xf
  v_and_b32_dpp v34, v80, v4 row_newbcast:12 row_mask:0xf bank_mask:0xf
  v_and_b32_dpp v35, v80, v5 row_newbcast:12 row_mask:0xf bank_mask:0xf
  s_waitcnt vmcnt(31)
  v_mfma_f32_16x16x32_bf16 v[36:39], v[216:219], v[28:31], v[36:39]
  buffer_load_dwordx4 v[216:219], v9, s[28:31], s72 offen nt
  s_addk_i32 s72, 0x1000
  s_cmp_ge_u32 s72, s14
  s_cselect_b32 s72, 0, s72
  v_and_b32_dpp v28, v81, v2 row_newbcast:0 row_mask:0xf bank_mask:0xf
  v_and_b32_dpp v29, v81, v3 row_newbcast:0 row_mask:0xf bank_mask:0xf
  v_and_b32_dpp v30, v81, v4 row_newbcast:0 row_mask:0xf bank_mask:0xf
  v_and_b32_dpp v31, v81, v5 row_newbcast:0 row_mask:0xf bank_mask:0xf
  s_waitcnt vmcnt(31)
  v_mfma_f32_16x16x32_bf16 v[36:39], v[220:223], v[32:35], v[36:39]
  buffer_load_dwordx4 v[220:223], v9, s[28:31], s72 offen nt
  s_addk_i32 s72, 0x1000
  s_cmp_ge_u32 s72, s14
  s_cselect_b32 s72, 0, s72
  v_and_b32_dpp v32, v81, v2 row_newbcast:4 row_mask:0xf bank_mask:0xf
  v_and_b32_dpp v33, v81, v3 row_newbcast:4 row_mask:0xf bank_mask:0xf
  v_and_b32_dpp v34, v81, v4 row_newbcast:4 row_mask:0xf bank_mask:0xf
  v_and_b32_dpp v35, v81, v5 row_newbcast:4 row_mask:0xf bank_mask:0xf
  s_waitcnt vmcnt(31)
  v_mfma_f32_16x16x32_bf16 v[36:39], v[224:227], v[28:31], v[36:39]
  buffer_load_dwordx4 v[224:227], v9, s[28:31], s72 offen nt
  s_addk_i32 s72, 0x1000
  s_cmp_ge_u32 s72, s14
  s_cselect_b32 s72, 0, s72
  v_and_b32_dpp v28, v81, v2 row_newbcast:8 row_mask:0xf bank_mask:0xf
  v_and_b32_dpp v29, v81, v3 row_newbcast:8 row_mask:0xf bank_mask:0xf
  v_and_b32_dpp v30, v81, v4 row_newbcast:8 row_mask:0xf bank_mask:0xf
  v_and_b32_dpp v31, v81, v5 row_newbcast:8 row_mask:0xf bank_mask:0xf
  s_waitcnt vmcnt(31)
  v_mfma_f32_16x16x32_bf16 v[36:39], v[228:231], v[32:35], v[36:39]
  buffer_load_dwordx4 v[228:231], v9, s[28:31], s72 offen nt
  s_addk_i32 s72, 0x1000
  s_cmp_ge_u32 s72, s14
  s_cselect_b32 s72, 0, s72
  v_and_b32_dpp v32, v81, v2 row_newbcast:12 row_mask:0xf bank_mask:0xf
  v_and_b32_dpp v33, v81, v3 row_newbcast:12 row_mask:0xf bank_mask:0xf
  v_and_b32_dpp v34, v81, v4 row_newbcast:12 row_mask:0xf bank_mask:0xf
  v_and_b32_dpp v35, v81, v5 row_newbcast:12 row_mask:0xf bank_mask:0xf
  s_waitcnt vmcnt(31)
  v_mfma_f32_16x16x32_bf16 v[36:39], v[232:235], v[28:31], v[36:39]
  buffer_load_dwordx4 v[232:235], v9, s[28:31], s72 offen nt
  s_addk_i32 s72, 0x1000
  s_cmp_ge_u32 s72, s14
  s_cselect_b32 s72, 0, s72
  v_and_b32_dpp v28, v82, v2 row_newbcast:0 row_mask:0xf bank_mask:0xf
  v_and_b32_dpp v29, v82, v3 row_newbcast:0 row_mask:0xf bank_mask:0xf
  v_and_b32_dpp v30, v82, v4 row_newbcast:0 row_mask:0xf bank_mask:0xf
  v_and_b32_dpp v31, v82, v5 row_newbcast:0 row_mask:0xf bank_mask:0xf
  s_waitcnt vmcnt(31)
  v_mfma_f32_16x16x32_bf16 v[36:39], v[236:239], v[32:35], v[36:39]
  buffer_load_dwordx4 v[236:239], v9, s[28:31], s72 offen nt
  s_addk_i32 s72, 0x1000
  s_cmp_ge_u32 s72, s14
  s_cselect_b32 s72, 0, s72
  v_and_b32_dpp v32, v82, v2 row_newbcast:4 row_mask:0xf bank_mask:0xf
  v_and_b32_dpp v33, v82, v3 row_newbcast:4 row_mask:0xf bank_mask:0xf
  v_and_b32_dpp v34, v82, v4 row_newbcast:4 row_mask:0xf bank_mask:0xf
  v_and_b32_dpp v35, v82, v5 row_newbcast:4 row_mask:0xf bank_mask:0xf
  s_waitcnt vmcnt(31)
  v_mfma_f32_16x16x32_bf16 v[36:39], v[240:243], v[28:31], v[36:39]
  buffer_load_dwordx4 v[240:243], v9, s[28:31], s72 offen nt
  s_addk_i32 s72, 0x1000
  s_cmp_ge_u32 s72, s14
  s_cselect_b32 s72, 0, s72
  v_and_b32_dpp v28, v82, v2 row_newbcast:8 row_mask:0xf bank_mask:0xf
  v_and_b32_dpp v29, v82, v3 row_newbcast:8 row_mask:0xf bank_mask:0xf
  v_and_b32_dpp v30, v82, v4 row_newbcast:8 row_mask:0xf bank_mask:0xf
  v_and_b32_dpp v31, v82, v5 row_newbcast:8 row_mask:0xf bank_mask:0xf
  s_waitcnt vmcnt(31)
  v_mfma_f32_16x16x32_bf16 v[36:39], v[244:247], v[32:35], v[36:39]
  buffer_load_dwordx4 v[244:247], v9, s[28:31], s72 offen nt
  s_addk_i32 s72, 0x1000
  s_cmp_ge_u32 s72, s14
  s_cselect_b32 s72, 0, s72
  v_and_b32_dpp v32, v82, v2 row_newbcast:12 row_mask:0xf bank_mask:0xf
  v_and_b32_dpp v33, v82, v3 row_newbcast:12 row_mask:0xf bank_mask:0xf
  v_and_b32_dpp v34, v82, v4 row_newbcast:12 row_mask:0xf bank_mask:0xf
  v_and_b32_dpp v35, v82, v5 row_newbcast:12 row_mask:0xf bank_mask:0xf
  s_waitcnt vmcnt(31)
  v_mfma_f32_16x16x32_bf16 v[36:39], v[248:251], v[28:31], v[36:39]
  buffer_load_dwordx4 v[248:251], v9, s[28:31], s72 offen nt
  s_addk_i32 s72, 0x1000
  s_cmp_ge_u32 s72, s14
  s_cselect_b32 s72, 0, s72
  v_and_b32_dpp v28, v83, v2 row_newbcast:0 row_mask:0xf bank_mask:0xf
  v_and_b32_dpp v29, v83, v3 row_newbcast:0 row_mask:0xf bank_mask:0xf
  v_and_b32_dpp v30, v83, v4 row_newbcast:0 row_mask:0xf bank_mask:0xf
  v_and_b32_dpp v31, v83, v5 row_newbcast:0 row_mask:0xf bank_mask:0xf
  s_waitcnt vmcnt(31)
  v_mfma_f32_16x16x32_bf16 v[36:39], v[252:255], v[32:35], v[36:39]
  buffer_load_dwordx4 v[252:255], v9, s[28:31], s72 offen nt
  s_addk_i32 s72, 0x1000
  s_cmp_ge_u32 s72, s14
  s_cselect_b32 s72, 0, s72
  v_and_b32_dpp v32, v83, v2 row_newbcast:4 row_mask:0xf bank_mask:0xf
  v_and_b32_dpp v33, v83, v3 row_newbcast:4 row_mask:0xf bank_mask:0xf
  v_and_b32_dpp v34, v83, v4 row_newbcast:4 row_mask:0xf bank_mask:0xf
  v_and_b32_dpp v35, v83, v5 row_newbcast:4 row_mask:0xf bank_mask:0xf
  s_waitcnt vmcnt(31)
  v_mfma_f32_16x16x32_bf16 v[36:39], v[128:131], v[28:31], v[36:39]
  buffer_load_dwordx4 v[128:131], v9, s[28:31], s72 offen nt
  s_addk_i32 s72, 0x1000
  s_cmp_ge_u32 s72, s14
  s_cselect_b32 s72, 0, s72
  v_and_b32_dpp v28, v83, v2 row_newbcast:8 row_mask:0xf bank_mask:0xf
  v_and_b32_dpp v29, v83, v3 row_newbcast:8 row_mask:0xf bank_mask:0xf
  v_and_b32_dpp v30, v83, v4 row_newbcast:8 row_mask:0xf bank_mask:0xf
  v_and_b32_dpp v31, v83, v5 row_newbcast:8 row_mask:0xf bank_mask:0xf
  s_waitcnt vmcnt(31)
  v_mfma_f32_16x16x32_bf16 v[36:39], v[132:135], v[32:35], v[36:39]
  buffer_load_dwordx4 v[132:135], v9, s[28:31], s72 offen nt
  s_addk_i32 s72, 0x1000
  s_cmp_ge_u32 s72, s14
  s_cselect_b32 s72, 0, s72
  v_and_b32_dpp v32, v83, v2 row_newbcast:12 row_mask:0xf bank_mask:0xf
  v_and_b32_dpp v33, v83, v3 row_newbcast:12 row_mask:0xf bank_mask:0xf
  v_and_b32_dpp v34, v83, v4 row_newbcast:12 row_mask:0xf bank_mask:0xf
  v_and_b32_dpp v35, v83, v5 row_newbcast:12 row_mask:0xf bank_mask:0xf
  s_waitcnt vmcnt(31)
  v_mfma_f32_16x16x32_bf16 v[36:39], v[136:139], v[28:31], v[36:39]
  buffer_load_dwordx4 v[136:139], v9, s[28:31], s72 offen nt
  s_addk_i32 s72, 0x1000
  s_cmp_ge_u32 s72, s14
  s_cselect_b32 s72, 0, s72
  v_and_b32_dpp v28, v84, v2 row_newbcast:0 row_mask:0xf bank_mask:0xf
  v_and_b32_dpp v29, v84, v3 row_newbcast:0 row_mask:0xf bank_mask:0xf
  v_and_b32_dpp v30, v84, v4 row_newbcast:0 row_mask:0xf bank_mask:0xf
  v_and_b32_dpp v31, v84, v5 row_newbcast:0 row_mask:0xf bank_mask:0xf
  s_waitcnt vmcnt(31)
  v_mfma_f32_16x16x32_bf16 v[36:39], v[140:143], v[32:35], v[36:39]
  buffer_load_dwordx4 v[140:143], v9, s[28:31], s72 offen nt
  s_addk_i32 s72, 0x1000
  s_cmp_ge_u32 s72, s14
  s_cselect_b32 s72, 0, s72
  v_and_b32_dpp v32, v84, v2 row_newbcast:4 row_mask:0xf bank_mask:0xf
  v_and_b32_dpp v33, v84, v3 row_newbcast:4 row_mask:0xf bank_mask:0xf
  v_and_b32_dpp v34, v84, v4 row_newbcast:4 row_mask:0xf bank_mask:0xf
  v_and_b32_dpp v35, v84, v5 row_newbcast:4 row_mask:0xf bank_mask:0xf
  s_waitcnt vmcnt(31)
  v_mfma_f32_16x16x32_bf16 v[36:39], v[144:147], v[28:31], v[36:39]
  buffer_load_dwordx4 v[144:147], v9, s[28:31], s72 offen nt
  s_addk_i32 s72, 0x1000
  s_cmp_ge_u32 s72, s14
  s_cselect_b32 s72, 0, s72
  v_mov_b32 v53, s83
  v_mov_b32 v124, 0
  v_mov_b32 v125, 0
  s_mov_b64 exec, 1
  buffer_load_dwordx2 v[124:125], v53, s[52:55], 0 offen sc1
  s_mov_b64 exec, -1
  v_and_b32_dpp v28, v84, v2 row_newbcast:8 row_mask:0xf bank_mask:0xf
  v_and_b32_dpp v29, v84, v3 row_newbcast:8 row_mask:0xf bank_mask:0xf
  v_and_b32_dpp v30, v84, v4 row_newbcast:8 row_mask:0xf bank_mask:0xf
  v_and_b32_dpp v31, v84, v5 row_newbcast:8 row_mask:0xf bank_mask:0xf
  s_waitcnt vmcnt(32)
  v_mfma_f32_16x16x32_bf16 v[36:39], v[148:151], v[32:35], v[36:39]
  buffer_load_dwordx4 v[148:151], v9, s[28:31], s72 offen nt
  s_addk_i32 s72, 0x1000
  s_cmp_ge_u32 s72, s14
  s_cselect_b32 s72, 0, s72
  v_and_b32_dpp v32, v84, v2 row_newbcast:12 row_mask:0xf bank_mask:0xf
  v_and_b32_dpp v33, v84, v3 row_newbcast:12 row_mask:0xf bank_mask:0xf
  v_and_b32_dpp v34, v84, v4 row_newbcast:12 row_mask:0xf bank_mask:0xf
  v_and_b32_dpp v35, v84, v5 row_newbcast:12 row_mask:0xf bank_mask:0xf
  s_waitcnt vmcnt(32)
  v_mfma_f32_16x16x32_bf16 v[36:39], v[152:155], v[28:31], v[36:39]
  buffer_load_dwordx4 v[152:155], v9, s[28:31], s72 offen nt
  s_addk_i32 s72, 0x1000
  s_cmp_ge_u32 s72, s14
  s_cselect_b32 s72, 0, s72
  v_and_b32_dpp v28, v85, v2 row_newbcast:0 row_mask:0xf bank_mask:0xf
  v_and_b32_dpp v29, v85, v3 row_newbcast:0 row_mask:0xf bank_mask:0xf
  v_and_b32_dpp v30, v85, v4 row_newbcast:0 row_mask:0xf bank_mask:0xf
  v_and_b32_dpp v31, v85, v5 row_newbcast:0 row_mask:0xf bank_mask:0xf
  s_waitcnt vmcnt(32)
  v_mfma_f32_16x16x32_bf16 v[36:39], v[156:159], v[32:35], v[36:39]
  buffer_load_dwordx4 v[156:159], v9, s[28:31], s72 offen nt
  s_addk_i32 s72, 0x1000
  s_cmp_ge_u32 s72, s14
  s_cselect_b32 s72, 0, s72
  v_and_b32_dpp v32, v85, v2 row_newbcast:4 row_mask:0xf bank_mask:0xf
  v_and_b32_dpp v33, v85, v3 row_newbcast:4 row_mask:0xf bank_mask:0xf
  v_and_b32_dpp v34, v85, v4 row_newbcast:4 row_mask:0xf bank_mask:0xf
  v_and_b32_dpp v35, v85, v5 row_newbcast:4 row_mask:0xf bank_mask:0xf
  s_waitcnt vmcnt(32)
  v_mfma_f32_16x16x32_bf16 v[36:39], v[160:163], v[28:31], v[36:39]
  buffer_load_dwordx4 v[160:163], v9, s[28:31], s72 offen nt
  s_addk_i32 s72, 0x1000
  s_cmp_ge_u32 s72, s14
  s_cselect_b32 s72, 0, s72
  v_and_b32_dpp v28, v85, v2 row_newbcast:8 row_mask:0xf bank_mask:0xf
  v_and_b32_dpp v29, v85, v3 row_newbcast:8 row_mask:0xf bank_mask:0xf
  v_and_b32_dpp v30, v85, v4 row_newbcast:8 row_mask:0xf bank_mask:0xf
  v_and_b32_dpp v31, v85, v5 row_newbcast:8 row_mask:0xf bank_mask:0xf
  s_waitcnt vmcnt(32)
  v_mfma_f32_16x16x32_bf16 v[36:39], v[164:167], v[32:35], v[36:39]
  buffer_load_dwordx4 v[164:167], v9, s[28:31], s72 offen nt
  s_addk_i32 s72, 0x1000
  s_cmp_ge_u32 s72, s14
  s_cselect_b32 s72, 0, s72
  v_and_b32_dpp v32, v85, v2 row_newbcast:12 row_mask:0xf bank_mask:0xf
  v_and_b32_dpp v33, v85, v3 row_newbcast:12 row_mask:0xf bank_mask:0xf
  v_and_b32_dpp v34, v85, v4 row_newbcast:12 row_mask:0xf bank_mask:0xf
  v_and_b32_dpp v35, v85, v5 row_newbcast:12 row_mask:0xf bank_mask:0xf
  s_waitcnt vmcnt(32)
  v_mfma_f32_16x16x32_bf16 v[36:39], v[168:171], v[28:31], v[36:39]
  buffer_load_dwordx4 v[168:171], v9, s[28:31], s72 offen nt
  s_addk_i32 s72, 0x1000
  s_cmp_ge_u32 s72, s14
  s_cselect_b32 s72, 0, s72
  v_and_b32_dpp v28, v86, v2 row_newbcast:0 row_mask:0xf bank_mask:0xf
  v_and_b32_dpp v29, v86, v3 row_newbcast:0 row_mask:0xf bank_mask:0xf
  v_and_b32_dpp v30, v86, v4 row_newbcast:0 row_mask:0xf bank_mask:0xf
  v_and_b32_dpp v31, v86, v5 row_newbcast:0 row_mask:0xf bank_mask:0xf
  s_waitcnt vmcnt(32)
  v_mfma_f32_16x16x32_bf16 v[36:39], v[172:175], v[32:35], v[36:39]
  buffer_load_dwordx4 v[172:175], v9, s[28:31], s72 offen nt
  s_addk_i32 s72, 0x1000
  s_cmp_ge_u32 s72, s14
  s_cselect_b32 s72, 0, s72
  v_and_b32_dpp v32, v86, v2 row_newbcast:4 row_mask:0xf bank_mask:0xf
  v_and_b32_dpp v33, v86, v3 row_newbcast:4 row_mask:0xf bank_mask:0xf
  v_and_b32_dpp v34, v86, v4 row_newbcast:4 row_mask:0xf bank_mask:0xf
  v_and_b32_dpp v35, v86, v5 row_newbcast:4 row_mask:0xf bank_mask:0xf
  s_waitcnt vmcnt(32)
  v_mfma_f32_16x16x32_bf16 v[36:39], v[176:179], v[28:31], v[36:39]
  buffer_load_dwordx4 v[176:179], v9, s[28:31], s72 offen nt
  s_addk_i32 s72, 0x1000
  s_cmp_ge_u32 s72, s14
  s_cselect_b32 s72, 0, s72
  v_and_b32_dpp v28, v86, v2 row_newbcast:8 row_mask:0xf bank_mask:0xf
  v_and_b32_dpp v29, v86, v3 row_newbcast:8 row_mask:0xf bank_mask:0xf
  v_and_b32_dpp v30, v86, v4 row_newbcast:8 row_mask:0xf bank_mask:0xf
  v_and_b32_dpp v31, v86, v5 row_newbcast:8 row_mask:0xf bank_mask:0xf
  s_waitcnt vmcnt(32)
  v_mfma_f32_16x16x32_bf16 v[36:39], v[180:183], v[32:35], v[36:39]
  buffer_load_dwordx4 v[180:183], v9, s[28:31], s72 offen nt
  s_addk_i32 s72, 0x1000
  s_cmp_ge_u32 s72, s14
  s_cselect_b32 s72, 0, s72
  v_and_b32_dpp v32, v86, v2 row_newbcast:12 row_mask:0xf bank_mask:0xf
  v_and_b32_dpp v33, v86, v3 row_newbcast:12 row_mask:0xf bank_mask:0xf
  v_and_b32_dpp v34, v86, v4 row_newbcast:12 row_mask:0xf bank_mask:0xf
  v_and_b32_dpp v35, v86, v5 row_newbcast:12 row_mask:0xf bank_mask:0xf
  s_waitcnt vmcnt(32)
  v_mfma_f32_16x16x32_bf16 v[36:39], v[184:187], v[28:31], v[36:39]
  buffer_load_dwordx4 v[184:187], v9, s[28:31], s72 offen nt
  s_addk_i32 s72, 0x1000
  s_cmp_ge_u32 s72, s14
  s_cselect_b32 s72, 0, s72
  v_and_b32_dpp v28, v87, v2 row_newbcast:0 row_mask:0xf bank_mask:0xf
  v_and_b32_dpp v29, v87, v3 row_newbcast:0 row_mask:0xf bank_mask:0xf
  v_and_b32_dpp v30, v87, v4 row_newbcast:0 row_mask:0xf bank_mask:0xf
  v_and_b32_dpp v31, v87, v5 row_newbcast:0 row_mask:0xf bank_mask:0xf
  s_waitcnt vmcnt(32)
  v_mfma_f32_16x16x32_bf16 v[36:39], v[188:191], v[32:35], v[36:39]
  buffer_load_dwordx4 v[188:191], v9, s[28:31], s72 offen nt
  s_addk_i32 s72, 0x1000
  s_cmp_ge_u32 s72, s14
  s_cselect_b32 s72, 0, s72
  v_and_b32_dpp v32, v87, v2 row_newbcast:4 row_mask:0xf bank_mask:0xf
  v_and_b32_dpp v33, v87, v3 row_newbcast:4 row_mask:0xf bank_mask:0xf
  v_and_b32_dpp v34, v87, v4 row_newbcast:4 row_mask:0xf bank_mask:0xf
  v_and_b32_dpp v35, v87, v5 row_newbcast:4 row_mask:0xf bank_mask:0xf
  s_waitcnt vmcnt(32)
  v_mfma_f32_16x16x32_bf16 v[36:39], v[192:195], v[28:31], v[36:39]
  buffer_load_dwordx4 v[192:195], v9, s[28:31], s72 offen nt
  s_addk_i32 s72, 0x1000
  s_cmp_ge_u32 s72, s14
  s_cselect_b32 s72, 0, s72
  v_and_b32_dpp v28, v87, v2 row_newbcast:8 row_mask:0xf bank_mask:0xf
  v_and_b32_dpp v29, v87, v3 row_newbcast:8 row_mask:0xf bank_mask:0xf
  v_and_b32_dpp v30, v87, v4 row_newbcast:8 row_mask:0xf bank_mask:0xf
  v_and_b32_dpp v31, v87, v5 row_newbcast:8 row_mask:0xf bank_mask:0xf
  s_waitcnt vmcnt(32)
  v_mfma_f32_16x16x32_bf16 v[36:39], v[196:199], v[32:35], v[36:39]
  buffer_load_dwordx4 v[196:199], v9, s[28:31], s72 offen nt
  s_addk_i32 s72, 0x1000
  s_cmp_ge_u32 s72, s14
  s_cselect_b32 s72, 0, s72
  v_and_b32_dpp v32, v87, v2 row_newbcast:12 row_mask:0xf bank_mask:0xf
  v_and_b32_dpp v33, v87, v3 row_newbcast:12 row_mask:0xf bank_mask:0xf
  v_and_b32_dpp v34, v87, v4 row_newbcast:12 row_mask:0xf bank_mask:0xf
  v_and_b32_dpp v35, v87, v5 row_newbcast:12 row_mask:0xf bank_mask:0xf
  s_waitcnt vmcnt(32)
  v_mfma_f32_16x16x32_bf16 v[36:39], v[200:203], v[28:31], v[36:39]
  buffer_load_dwordx4 v[200:203], v9, s[28:31], s72 offen nt
  s_addk_i32 s72, 0x1000
  s_cmp_ge_u32 s72, s14
  s_cselect_b32 s72, 0, s72
  v_and_b32_dpp v28, v88, v2 row_newbcast:0 row_mask:0xf bank_mask:0xf
  v_and_b32_dpp v29, v88, v3 row_newbcast:0 row_mask:0xf bank_mask:0xf
  v_and_b32_dpp v30, v88, v4 row_newbcast:0 row_mask:0xf bank_mask:0xf
  v_and_b32_dpp v31, v88, v5 row_newbcast:0 row_mask:0xf bank_mask:0xf
  s_waitcnt vmcnt(32)
  v_mfma_f32_16x16x32_bf16 v[36:39], v[204:207], v[32:35], v[36:39]
  buffer_load_dwordx4 v[204:207], v9, s[28:31], s72 offen nt
  s_addk_i32 s72, 0x1000
  s_cmp_ge_u32 s72, s14
  s_cselect_b32 s72, 0, s72
  v_and_b32_dpp v32, v88, v2 row_newbcast:4 row_mask:0xf bank_mask:0xf
  v_and_b32_dpp v33, v88, v3 row_newbcast:4 row_mask:0xf bank_mask:0xf
  v_and_b32_dpp v34, v88, v4 row_newbcast:4 row_mask:0xf bank_mask:0xf
  v_and_b32_dpp v35, v88, v5 row_newbcast:4 row_mask:0xf bank_mask:0xf
  s_waitcnt vmcnt(32)
  v_mfma_f32_16x16x32_bf16 v[36:39], v[208:211], v[28:31], v[36:39]
  buffer_load_dwordx4 v[208:211], v9, s[28:31], s72 offen nt
  s_addk_i32 s72, 0x1000
  s_cmp_ge_u32 s72, s14
  s_cselect_b32 s72, 0, s72
  v_and_b32_dpp v28, v88, v2 row_newbcast:8 row_mask:0xf bank_mask:0xf
  v_and_b32_dpp v29, v88, v3 row_newbcast:8 row_mask:0xf bank_mask:0xf
  v_and_b32_dpp v30, v88, v4 row_newbcast:8 row_mask:0xf bank_mask:0xf
  v_and_b32_dpp v31, v88, v5 row_newbcast:8 row_mask:0xf bank_mask:0xf
  s_waitcnt vmcnt(32)
  v_mfma_f32_16x16x32_bf16 v[36:39], v[212:215], v[32:35], v[36:39]
  buffer_load_dwordx4 v[212:215], v9, s[28:31], s72 offen nt
  s_addk_i32 s72, 0x1000
  s_cmp_ge_u32 s72, s14
  s_cselect_b32 s72, 0, s72
  v_and_b32_dpp v32, v88, v2 row_newbcast:12 row_mask:0xf bank_mask:0xf
  v_and_b32_dpp v33, v88, v3 row_newbcast:12 row_mask:0xf bank_mask:0xf
  v_and_b32_dpp v34, v88, v4 row_newbcast:12 row_mask:0xf bank_mask:0xf
  v_and_b32_dpp v35, v88, v5 row_newbcast:12 row_mask:0xf bank_mask:0xf
  s_waitcnt vmcnt(32)
  v_mfma_f32_16x16x32_bf16 v[36:39], v[216:219], v[28:31], v[36:39]
  buffer_load_dwordx4 v[216:219], v9, s[28:31], s72 offen nt
  s_addk_i32 s72, 0x1000
  s_cmp_ge_u32 s72, s14
  s_cselect_b32 s72, 0, s72
  v_and_b32_dpp v28, v89, v2 row_newbcast:0 row_mask:0xf bank_mask:0xf
  v_and_b32_dpp v29, v89, v3 row_newbcast:0 row_mask:0xf bank_mask:0xf
  v_and_b32_dpp v30, v89, v4 row_newbcast:0 row_mask:0xf bank_mask:0xf
  v_and_b32_dpp v31, v89, v5 row_newbcast:0 row_mask:0xf bank_mask:0xf
  s_waitcnt vmcnt(32)
  v_mfma_f32_16x16x32_bf16 v[36:39], v[220:223], v[32:35], v[36:39]
  buffer_load_dwordx4 v[220:223], v9, s[28:31], s72 offen nt
  s_addk_i32 s72, 0x1000
  s_cmp_ge_u32 s72, s14
  s_cselect_b32 s72, 0, s72
  v_and_b32_dpp v32, v89, v2 row_newbcast:4 row_mask:0xf bank_mask:0xf
  v_and_b32_dpp v33, v89, v3 row_newbcast:4 row_mask:0xf bank_mask:0xf
  v_and_b32_dpp v34, v89, v4 row_newbcast:4 row_mask:0xf bank_mask:0xf
  v_and_b32_dpp v35, v89, v5 row_newbcast:4 row_mask:0xf bank_mask:0xf
  s_waitcnt vmcnt(32)
  v_mfma_f32_16x16x32_bf16 v[36:39], v[224:227], v[28:31], v[36:39]
  v_and_b32_dpp v28, v89, v2 row_newbcast:8 row_mask:0xf bank_mask:0xf
  v_and_b32_dpp v29, v89, v3 row_newbcast:8 row_mask:0xf bank_mask:0xf
  v_and_b32_dpp v30, v89, v4 row_newbcast:8 row_mask:0xf bank_mask:0xf
  v_and_b32_dpp v31, v89, v5 row_newbcast:8 row_mask:0xf bank_mask:0xf
  s_waitcnt vmcnt(31)
  v_mfma_f32_16x16x32_bf16 v[36:39], v[228:231], v[32:35], v[36:39]
  v_and_b32_dpp v32, v89, v2 row_newbcast:12 row_mask:0xf bank_mask:0xf
  v_and_b32_dpp v33, v89, v3 row_newbcast:12 row_mask:0xf bank_mask:0xf
  v_and_b32_dpp v34, v89, v4 row_newbcast:12 row_mask:0xf bank_mask:0xf
  v_and_b32_dpp v35, v89, v5 row_newbcast:12 row_mask:0xf bank_mask:0xf
  s_waitcnt vmcnt(30)
  v_mfma_f32_16x16x32_bf16 v[36:39], v[232:235], v[28:31], v[36:39]
  v_and_b32_dpp v28, v90, v2 row_newbcast:0 row_mask:0xf bank_mask:0xf
  v_and_b32_dpp v29, v90, v3 row_newbcast:0 row_mask:0xf bank_mask:0xf
  v_and_b32_dpp v30, v90, v4 row_newbcast:0 row_mask:0xf bank_mask:0xf
  v_and_b32_dpp v31, v90, v5 row_newbcast:0 row_mask:0xf bank_mask:0xf
  s_waitcnt vmcnt(29)
  v_mfma_f32_16x16x32_bf16 v[36:39], v[236:239], v[32:35], v[36:39]
  v_and_b32_dpp v32, v90, v2 row_newbcast:4 row_mask:0xf bank_mask:0xf
  v_and_b32_dpp v33, v90, v3 row_newbcast:4 row_mask:0xf bank_mask:0xf
  v_and_b32_dpp v34, v90, v4 row_newbcast:4 row_mask:0xf bank_mask:0xf
  v_and_b32_dpp v35, v90, v5 row_newbcast:4 row_mask:0xf bank_mask:0xf
  s_waitcnt vmcnt(28)
  v_mfma_f32_16x16x32_bf16 v[36:39], v[240:243], v[28:31], v[36:39]
  v_and_b32_dpp v28, v90, v2 row_newbcast:8 row_mask:0xf bank_mask:0xf
  v_and_b32_dpp v29, v90, v3 row_newbcast:8 row_mask:0xf bank_mask:0xf
  v_and_b32_dpp v30, v90, v4 row_newbcast:8 row_mask:0xf bank_mask:0xf
  v_and_b32_dpp v31, v90, v5 row_newbcast:8 row_mask:0xf bank_mask:0xf
  s_waitcnt vmcnt(27)
  v_mfma_f32_16x16x32_bf16 v[36:39], v[244:247], v[32:35], v[36:39]
  v_and_b32_dpp v32, v90, v2 row_newbcast:12 row_mask:0xf bank_mask:0xf
  v_and_b32_dpp v33, v90, v3 row_newbcast:12 row_mask:0xf bank_mask:0xf
  v_and_b32_dpp v34, v90, v4 row_newbcast:12 row_mask:0xf bank_mask:0xf
  v_and_b32_dpp v35, v90, v5 row_newbcast:12 row_mask:0xf bank_mask:0xf
  s_waitcnt vmcnt(26)
  v_mfma_f32_16x16x32_bf16 v[36:39], v[248:251], v[28:31], v[36:39]
  v_and_b32_dpp v28, v91, v2 row_newbcast:0 row_mask:0xf bank_mask:0xf
  v_and_b32_dpp v29, v91, v3 row_newbcast:0 row_mask:0xf bank_mask:0xf
  v_and_b32_dpp v30, v91, v4 row_newbcast:0 row_mask:0xf bank_mask:0xf
  v_and_b32_dpp v31, v91, v5 row_newbcast:0 row_mask:0xf bank_mask:0xf
  s_waitcnt vmcnt(25)
  v_mfma_f32_16x16x32_bf16 v[36:39], v[252:255], v[32:35], v[36:39]
  v_and_b32_dpp v32, v91, v2 row_newbcast:4 row_mask:0xf bank_mask:0xf
  v_and_b32_dpp v33, v91, v3 row_newbcast:4 row_mask:0xf bank_mask:0xf
  v_and_b32_dpp v34, v91, v4 row_newbcast:4 row_mask:0xf bank_mask:0xf
  v_and_b32_dpp v35, v91, v5 row_newbcast:4 row_mask:0xf bank_mask:0xf
  s_waitcnt vmcnt(24)
  v_mfma_f32_16x16x32_bf16 v[36:39], v[128:131], v[28:31], v[36:39]
  v_and_b32_dpp v28, v91, v2 row_newbcast:8 row_mask:0xf bank_mask:0xf
  v_and_b32_dpp v29, v91, v3 row_newbcast:8 row_mask:0xf bank_mask:0xf
  v_and_b32_dpp v30, v91, v4 row_newbcast:8 row_mask:0xf bank_mask:0xf
  v_and_b32_dpp v31, v91, v5 row_newbcast:8 row_mask:0xf bank_mask:0xf
  s_waitcnt vmcnt(23)
  v_mfma_f32_16x16x32_bf16 v[36:39], v[132:135], v[32:35], v[36:39]
  v_and_b32_dpp v32, v91, v2 row_newbcast:12 row_mask:0xf bank_mask:0xf
  v_and_b32_dpp v33, v91, v3 row_newbcast:12 row_mask:0xf bank_mask:0xf
  v_and_b32_dpp v34, v91, v4 row_newbcast:12 row_mask:0xf bank_mask:0xf
  v_and_b32_dpp v35, v91, v5 row_newbcast:12 row_mask:0xf bank_mask:0xf
  s_waitcnt vmcnt(22)
  v_mfma_f32_16x16x32_bf16 v[36:39], v[136:139], v[28:31], v[36:39]
  v_and_b32_dpp v28, v92, v2 row_newbcast:0 row_mask:0xf bank_mask:0xf
  v_and_b32_dpp v29, v92, v3 row_newbcast:0 row_mask:0xf bank_mask:0xf
  v_and_b32_dpp v30, v92, v4 row_newbcast:0 row_mask:0xf bank_mask:0xf
  v_and_b32_dpp v31, v92, v5 row_newbcast:0 row_mask:0xf bank_mask:0xf
  s_waitcnt vmcnt(21)
  v_mfma_f32_16x16x32_bf16 v[36:39], v[140:143], v[32:35], v[36:39]
  v_and_b32_dpp v32, v92, v2 row_newbcast:4 row_mask:0xf bank_mask:0xf
  v_and_b32_dpp v33, v92, v3 row_newbcast:4 row_mask:0xf bank_mask:0xf
  v_and_b32_dpp v34, v92, v4 row_newbcast:4 row_mask:0xf bank_mask:0xf
  v_and_b32_dpp v35, v92, v5 row_newbcast:4 row_mask:0xf bank_mask:0xf
  s_waitcnt vmcnt(20)
  v_mfma_f32_16x16x32_bf16 v[36:39], v[144:147], v[28:31], v[36:39]
  v_mov_b32 v116, v106
  v_mov_b32 v117, v107
  v_mov_b32 v118, v108
  v_mov_b32 v119, v109
  s_mov_b32 s74, 16384
  s_mov_b32 exec_lo, 0x01ff01ff
  s_mov_b32 exec_hi, 0x01ff01ff
  buffer_atomic_add_f32 v116, v60, s[52:55], s74 offen offset:0 sc0
  buffer_atomic_add_f32 v117, v60, s[52:55], s74 offen offset:64 sc0
  buffer_atomic_add_f32 v118, v60, s[52:55], s74 offen offset:128 sc0
  buffer_atomic_add_f32 v119, v60, s[52:55], s74 offen offset:192 sc0
  s_mov_b64 exec, -1
  v_and_b32_dpp v28, v92, v2 row_newbcast:8 row_mask:0xf bank_mask:0xf
  v_and_b32_dpp v29, v92, v3 row_newbcast:8 row_mask:0xf bank_mask:0xf
  v_and_b32_dpp v30, v92, v4 row_newbcast:8 row_mask:0xf bank_mask:0xf
  v_and_b32_dpp v31, v92, v5 row_newbcast:8 row_mask:0xf bank_mask:0xf
  s_waitcnt vmcnt(22)
  v_mfma_f32_16x16x32_bf16 v[36:39], v[148:151], v[32:35], v[36:39]
  v_and_b32_dpp v32, v92, v2 row_newbcast:12 row_mask:0xf bank_mask:0xf
  v_and_b32_dpp v33, v92, v3 row_newbcast:12 row_mask:0xf bank_mask:0xf
  v_and_b32_dpp v34, v92, v4 row_newbcast:12 row_mask:0xf bank_mask:0xf
  v_and_b32_dpp v35, v92, v5 row_newbcast:12 row_mask:0xf bank_mask:0xf
  s_waitcnt vmcnt(21)
  v_mfma_f32_16x16x32_bf16 v[36:39], v[152:155], v[28:31], v[36:39]
  v_and_b32_dpp v28, v93, v2 row_newbcast:0 row_mask:0xf bank_mask:0xf
  v_and_b32_dpp v29, v93, v3 row_newbcast:0 row_mask:0xf bank_mask:0xf
  v_and_b32_dpp v30, v93, v4 row_newbcast:0 row_mask:0xf bank_mask:0xf
  v_and_b32_dpp v31, v93, v5 row_newbcast:0 row_mask:0xf bank_mask:0xf
  s_waitcnt vmcnt(20)
  v_mfma_f32_16x16x32_bf16 v[36:39], v[156:159], v[32:35], v[36:39]
  v_and_b32_dpp v32, v93, v2 row_newbcast:4 row_mask:0xf bank_mask:0xf
  v_and_b32_dpp v33, v93, v3 row_newbcast:4 row_mask:0xf bank_mask:0xf
  v_and_b32_dpp v34, v93, v4 row_newbcast:4 row_mask:0xf bank_mask:0xf
  v_and_b32_dpp v35, v93, v5 row_newbcast:4 row_mask:0xf bank_mask:0xf
  s_waitcnt vmcnt(19)
  v_mfma_f32_16x16x32_bf16 v[36:39], v[160:163], v[28:31], v[36:39]
  v_and_b32_dpp v28, v93, v2 row_newbcast:8 row_mask:0xf bank_mask:0xf
  v_and_b32_dpp v29, v93, v3 row_newbcast:8 row_mask:0xf bank_mask:0xf
  v_and_b32_dpp v30, v93, v4 row_newbcast:8 row_mask:0xf bank_mask:0xf
  v_and_b32_dpp v31, v93, v5 row_newbcast:8 row_mask:0xf bank_mask:0xf
  s_waitcnt vmcnt(18)
  v_mfma_f32_16x16x32_bf16 v[36:39], v[164:167], v[32:35], v[36:39]
  v_and_b32_dpp v32, v93, v2 row_newbcast:12 row_mask:0xf bank_mask:0xf
  v_and_b32_dpp v33, v93, v3 row_newbcast:12 row_mask:0xf bank_mask:0xf
  v_and_b32_dpp v34, v93, v4 row_newbcast:12 row_mask:0xf bank_mask:0xf
  v_and_b32_dpp v35, v93, v5 row_newbcast:12 row_mask:0xf bank_mask:0xf
  s_waitcnt vmcnt(17)
  v_mfma_f32_16x16x32_bf16 v[36:39], v[168:171], v[28:31], v[36:39]
  v_and_b32_dpp v28, v94, v2 row_newbcast:0 row_mask:0xf bank_mask:0xf
  v_and_b32_dpp v29, v94, v3 row_newbcast:0 row_mask:0xf bank_mask:0xf
  v_and_b32_dpp v30, v94, v4 row_newbcast:0 row_mask:0xf bank_mask:0xf
  v_and_b32_dpp v31, v94, v5 row_newbcast:0 row_mask:0xf bank_mask:0xf
  s_waitcnt vmcnt(16)
  v_mfma_f32_16x16x32_bf16 v[36:39], v[172:175], v[32:35], v[36:39]
  v_and_b32_dpp v32, v94, v2 row_newbcast:4 row_mask:0xf bank_mask:0xf
  v_and_b32_dpp v33, v94, v3 row_newbcast:4 row_mask:0xf bank_mask:0xf
  v_and_b32_dpp v34, v94, v4 row_newbcast:4 row_mask:0xf bank_mask:0xf
  v_and_b32_dpp v35, v94, v5 row_newbcast:4 row_mask:0xf bank_mask:0xf
  s_waitcnt vmcnt(15)
  v_mfma_f32_16x16x32_bf16 v[36:39], v[176:179], v[28:31], v[36:39]
  v_and_b32_dpp v28, v94, v2 row_newbcast:8 row_mask:0xf bank_mask:0xf
  v_and_b32_dpp v29, v94, v3 row_newbcast:8 row_mask:0xf bank_mask:0xf
  v_and_b32_dpp v30, v94, v4 row_newbcast:8 row_mask:0xf bank_mask:0xf
  v_and_b32_dpp v31, v94, v5 row_newbcast:8 row_mask:0xf bank_mask:0xf
  s_waitcnt vmcnt(14)
  v_mfma_f32_16x16x32_bf16 v[36:39], v[180:183], v[32:35], v[36:39]
  v_and_b32_dpp v32, v94, v2 row_newbcast:12 row_mask:0xf bank_mask:0xf
  v_and_b32_dpp v33, v94, v3 row_newbcast:12 row_mask:0xf bank_mask:0xf
  v_and_b32_dpp v34, v94, v4 row_newbcast:12 row_mask:0xf bank_mask:0xf
  v_and_b32_dpp v35, v94, v5 row_newbcast:12 row_mask:0xf bank_mask:0xf
  s_waitcnt vmcnt(13)
  v_mfma_f32_16x16x32_bf16 v[36:39], v[184:187], v[28:31], v[36:39]
  v_and_b32_dpp v28, v95, v2 row_newbcast:0 row_mask:0xf bank_mask:0xf
  v_and_b32_dpp v29, v95, v3 row_newbcast:0 row_mask:0xf bank_mask:0xf
  v_and_b32_dpp v30, v95, v4 row_newbcast:0 row_mask:0xf bank_mask:0xf
  v_and_b32_dpp v31, v95, v5 row_newbcast:0 row_mask:0xf bank_mask:0xf
  s_waitcnt vmcnt(12)
  v_mfma_f32_16x16x32_bf16 v[36:39], v[188:191], v[32:35], v[36:39]
  v_and_b32_dpp v32, v95, v2 row_newbcast:4 row_mask:0xf bank_mask:0xf
  v_and_b32_dpp v33, v95, v3 row_newbcast:4 row_mask:0xf bank_mask:0xf
  v_and_b32_dpp v34, v95, v4 row_newbcast:4 row_mask:0xf bank_mask:0xf
  v_and_b32_dpp v35, v95, v5 row_newbcast:4 row_mask:0xf bank_mask:0xf
  s_waitcnt vmcnt(11)
  v_mfma_f32_16x16x32_bf16 v[36:39], v[192:195], v[28:31], v[36:39]
  v_and_b32_dpp v28, v95, v2 row_newbcast:8 row_mask:0xf bank_mask:0xf
  v_and_b32_dpp v29, v95, v3 row_newbcast:8 row_mask:0xf bank_mask:0xf
  v_and_b32_dpp v30, v95, v4 row_newbcast:8 row_mask:0xf bank_mask:0xf
  v_and_b32_dpp v31, v95, v5 row_newbcast:8 row_mask:0xf bank_mask:0xf
  s_waitcnt vmcnt(10)
  v_mfma_f32_16x16x32_bf16 v[36:39], v[196:199], v[32:35], v[36:39]
  v_and_b32_dpp v32, v95, v2 row_newbcast:12 row_mask:0xf bank_mask:0xf
  v_and_b32_dpp v33, v95, v3 row_newbcast:12 row_mask:0xf bank_mask:0xf
  v_and_b32_dpp v34, v95, v4 row_newbcast:12 row_mask:0xf bank_mask:0xf
  v_and_b32_dpp v35, v95, v5 row_newbcast:12 row_mask:0xf bank_mask:0xf
  s_waitcnt vmcnt(9)
  v_mfma_f32_16x16x32_bf16 v[36:39], v[200:203], v[28:31], v[36:39]
  v_and_b32_dpp v28, v96, v2 row_newbcast:0 row_mask:0xf bank_mask:0xf
  v_and_b32_dpp v29, v96, v3 row_newbcast:0 row_mask:0xf bank_mask:0xf
  v_and_b32_dpp v30, v96, v4 row_newbcast:0 row_mask:0xf bank_mask:0xf
  v_and_b32_dpp v31, v96, v5 row_newbcast:0 row_mask:0xf bank_mask:0xf
  s_waitcnt vmcnt(8)
  v_mfma_f32_16x16x32_bf16 v[36:39], v[204:207], v[32:35], v[36:39]
  v_and_b32_dpp v32, v96, v2 row_newbcast:4 row_mask:0xf bank_mask:0xf
  v_and_b32_dpp v33, v96, v3 row_newbcast:4 row_mask:0xf bank_mask:0xf
  v_and_b32_dpp v34, v96, v4 row_newbcast:4 row_mask:0xf bank_mask:0xf
  v_and_b32_dpp v35, v96, v5 row_newbcast:4 row_mask:0xf bank_mask:0xf
  s_waitcnt vmcnt(7)
  v_mfma_f32_16x16x32_bf16 v[36:39], v[208:211], v[28:31], v[36:39]
  v_and_b32_dpp v28, v96, v2 row_newbcast:8 row_mask:0xf bank_mask:0xf
  v_and_b32_dpp v29, v96, v3 row_newbcast:8 row_mask:0xf bank_mask:0xf
  v_and_b32_dpp v30, v96, v4 row_newbcast:8 row_mask:0xf bank_mask:0xf
  v_and_b32_dpp v31, v96, v5 row_newbcast:8 row_mask:0xf bank_mask:0xf
  s_waitcnt vmcnt(6)
  v_mfma_f32_16x16x32_bf16 v[36:39], v[212:215], v[32:35], v[36:39]
  v_and_b32_dpp v32, v96, v2 row_newbcast:12 row_mask:0xf bank_mask:0xf
  v_and_b32_dpp v33, v96, v3 row_newbcast:12 row_mask:0xf bank_mask:0xf
  v_and_b32_dpp v34, v96, v4 row_newbcast:12 row_mask:0xf bank_mask:0xf
  v_and_b32_dpp v35, v96, v5 row_newbcast:12 row_mask:0xf bank_mask:0xf
  s_waitcnt vmcnt(5)
  v_mfma_f32_16x16x32_bf16 v[36:39], v[216:219], v[28:31], v[36:39]
  s_nop 1
  s_waitcnt vmcnt(4)
  v_mfma_f32_16x16x32_bf16 v[36:39], v[220:223], v[32:35], v[36:39]
  s_lshl_b32 s74, s64, 9
  s_addk_i32 s74, 4096
  v_lshlrev_b32 v56, 7, v44
  v_lshl_add_u32 v56, v45, 2, v56
  v_add_u32 v56, s74, v56
  v_lshl_add_u32 v57, v44, 5, v45
  v_lshlrev_b32 v57, 2, v57
  v_mov_b32 v26, 0
  s_nop 1
  v_mul_f32 v36, v122, v36
  v_mul_f32 v37, v122, v37
  v_mul_f32 v38, v122, v38
  v_mul_f32 v39, v122, v39
  s_mov_b32 exec_lo, 0x00ff00ff
  s_mov_b32 exec_hi, 0x00ff00ff
  ds_write_b32 v56, v36 offset:0
  ds_write_b32 v56, v37 offset:32
  ds_write_b32 v56, v38 offset:64
  ds_write_b32 v56, v39 offset:96
  s_mov_b64 exec, -1
  s_cmp_lg_u32 s64, 0
  s_cbranch_scc1 L_pok
L_pchk:
  v_readfirstlane_b32 s74, v125
  s_nop 3
  s_cmp_lg_u32 s74, 0
  s_cbranch_scc1 L_pgot
  s_sleep 4
  v_mov_b32 v124, 0
  v_mov_b32 v125, 0
  s_mov_b64 exec, 1
  buffer_atomic_or_x2 v[124:125], v53, s[52:55], 0 offen sc0
  s_waitcnt vmcnt(0)
  s_mov_b64 exec, -1
  s_branch L_pchk
L_pgot:
  s_mov_b64 exec, 1
  ds_write_b64 v26, v[124:125] offset:6144
  s_mov_b64 exec, -1
L_pok:
  s_waitcnt lgkmcnt(0)
  s_barrier
  ds_read_b64 v[124:125], v26 offset:6144
  ds_read_b32 v64, v57 offset:4096
  ds_read_b32 v65, v57 offset:4160
  ds_read_b32 v66, v57 offset:4608
  ds_read_b32 v67, v57 offset:4672
  ds_read_b32 v68, v57 offset:5120
  ds_read_b32 v69, v57 offset:5184
  ds_read_b32 v70, v57 offset:5632
  ds_read_b32 v71, v57 offset:5696
  s_waitcnt lgkmcnt(8)
  v_max_f32 v72, v120, v124
  v_sub_f32 v73, v120, v72
  v_sub_f32 v74, v124, v72
  v_mul_f32 v73, s82, v73
  v_mul_f32 v74, s82, v74
  v_exp_f32 v73, v73
  v_exp_f32 v74, v74
  s_nop 0
  v_mul_f32 v75, v73, v121
  v_fmac_f32 v75, v74, v125
  v_rcp_f32 v75, v75
  s_nop 0
  v_mul_f32 v73, v73, v75
  s_waitcnt lgkmcnt(0)
  v_add_f32 v64, v64, v66
  v_add_f32 v65, v65, v67
  v_add_f32 v68, v68, v70
  v_add_f32 v69, v69, v71
  v_add_f32 v76, v64, v68
  v_add_f32 v77, v65, v69
  v_mul_f32 v76, v76, v73
  v_mul_f32 v77, v77, v73
  v_cvt_pk_bf16_f32 v76, v76, v76
  v_cvt_pk_bf16_f32 v77, v77, v77
  s_nop 1
  v_and_b32_dpp v28, v76, v2 row_newbcast:0 row_mask:0xf bank_mask:0xf
  v_and_b32_dpp v29, v76, v3 row_newbcast:0 row_mask:0xf bank_mask:0xf
  v_and_b32_dpp v30, v76, v4 row_newbcast:0 row_mask:0xf bank_mask:0xf
  v_and_b32_dpp v31, v76, v5 row_newbcast:0 row_mask:0xf bank_mask:0xf
  v_and_b32_dpp v32, v76, v2 row_newbcast:1 row_mask:0xf bank_mask:0xf
  v_and_b32_dpp v33, v76, v3 row_newbcast:1 row_mask:0xf bank_mask:0xf
  v_and_b32_dpp v34, v76, v4 row_newbcast:1 row_mask:0xf bank_mask:0xf
  v_and_b32_dpp v35, v76, v5 row_newbcast:1 row_mask:0xf bank_mask:0xf
  v_mfma_f32_16x16x32_bf16 v[40:43], a[0:3], v[28:31], 0
  v_and_b32_dpp v28, v76, v2 row_newbcast:2 row_mask:0xf bank_mask:0xf
  v_and_b32_dpp v29, v76, v3 row_newbcast:2 row_mask:0xf bank_mask:0xf
  v_and_b32_dpp v30, v76, v4 row_newbcast:2 row_mask:0xf bank_mask:0xf
  v_and_b32_dpp v31, v76, v5 row_newbcast:2 row_mask:0xf bank_mask:0xf
  v_mfma_f32_16x16x32_bf16 v[40:43], a[4:7], v[32:35], v[40:43]
  v_and_b32_dpp v32, v76, v2 row_newbcast:3 row_mask:0xf bank_mask:0xf
  v_and_b32_dpp v33, v76, v3 row_newbcast:3 row_mask:0xf bank_mask:0xf
  v_and_b32_dpp v34, v76, v4 row_newbcast:3 row_mask:0xf bank_mask:0xf
  v_and_b32_dpp v35, v76, v5 row_newbcast:3 row_mask:0xf bank_mask:0xf
  v_mfma_f32_16x16x32_bf16 v[40:43], a[8:11], v[28:31], v[40:43]
  v_and_b32_dpp v28, v76, v2 row_newbcast:4 row_mask:0xf bank_mask:0xf
  v_and_b32_dpp v29, v76, v3 row_newbcast:4 row_mask:0xf bank_mask:0xf
  v_and_b32_dpp v30, v76, v4 row_newbcast:4 row_mask:0xf bank_mask:0xf
  v_and_b32_dpp v31, v76, v5 row_newbcast:4 row_mask:0xf bank_mask:0xf
  v_mfma_f32_16x16x32_bf16 v[40:43], a[12:15], v[32:35], v[40:43]
  v_and_b32_dpp v32, v76, v2 row_newbcast:5 row_mask:0xf bank_mask:0xf
  v_and_b32_dpp v33, v76, v3 row_newbcast:5 row_mask:0xf bank_mask:0xf
  v_and_b32_dpp v34, v76, v4 row_newbcast:5 row_mask:0xf bank_mask:0xf
  v_and_b32_dpp v35, v76, v5 row_newbcast:5 row_mask:0xf bank_mask:0xf
  v_mfma_f32_16x16x32_bf16 v[40:43], a[16:19], v[28:31], v[40:43]
  v_and_b32_dpp v28, v76, v2 row_newbcast:6 row_mask:0xf bank_mask:0xf
  v_and_b32_dpp v29, v76, v3 row_newbcast:6 row_mask:0xf bank_mask:0xf
  v_and_b32_dpp v30, v76, v4 row_newbcast:6 row_mask:0xf bank_mask:0xf
  v_and_b32_dpp v31, v76, v5 row_newbcast:6 row_mask:0xf bank_mask:0xf
  v_mfma_f32_16x16x32_bf16 v[40:43], a[20:23], v[32:35], v[40:43]
  v_and_b32_dpp v32, v76, v2 row_newbcast:7 row_mask:0xf bank_mask:0xf
  v_and_b32_dpp v33, v76, v3 row_newbcast:7 row_mask:0xf bank_mask:0xf
  v_and_b32_dpp v34, v76, v4 row_newbcast:7 row_mask:0xf bank_mask:0xf
  v_and_b32_dpp v35, v76, v5 row_newbcast:7 row_mask:0xf bank_mask:0xf
  v_mfma_f32_16x16x32_bf16 v[40:43], a[24:27], v[28:31], v[40:43]
  v_and_b32_dpp v28, v76, v2 row_newbcast:8 row_mask:0xf bank_mask:0xf
  v_and_b32_dpp v29, v76, v3 row_newbcast:8 row_mask:0xf bank_mask:0xf
  v_and_b32_dpp v30, v76, v4 row_newbcast:8 row_mask:0xf bank_mask:0xf
  v_and_b32_dpp v31, v76, v5 row_newbcast:8 row_mask:0xf bank_mask:0xf
  v_mfma_f32_16x16x32_bf16 v[40:43], a[28:31], v[32:35], v[40:43]
  v_and_b32_dpp v32, v76, v2 row_newbcast:9 row_mask:0xf bank_mask:0xf
  v_and_b32_dpp v33, v76, v3 row_newbcast:9 row_mask:0xf bank_mask:0xf
  v_and_b32_dpp v34, v76, v4 row_newbcast:9 row_mask:0xf bank_mask:0xf
  v_and_b32_dpp v35, v76, v5 row_newbcast:9 row_mask:0xf bank_mask:0xf
  v_mfma_f32_16x16x32_bf16 v[40:43], a[32:35], v[28:31], v[40:43]
  v_and_b32_dpp v28, v76, v2 row_newbcast:10 row_mask:0xf bank_mask:0xf
  v_and_b32_dpp v29, v76, v3 row_newbcast:10 row_mask:0xf bank_mask:0xf
  v_and_b32_dpp v30, v76, v4 row_newbcast:10 row_mask:0xf bank_mask:0xf
  v_and_b32_dpp v31, v76, v5 row_newbcast:10 row_mask:0xf bank_mask:0xf
  v_mfma_f32_16x16x32_bf16 v[40:43], a[36:39], v[32:35], v[40:43]
  v_and_b32_dpp v32, v76, v2 row_newbcast:11 row_mask:0xf bank_mask:0xf
  v_and_b32_dpp v33, v76, v3 row_newbcast:11 row_mask:0xf bank_mask:0xf
  v_and_b32_dpp v34, v76, v4 row_newbcast:11 row_mask:0xf bank_mask:0xf
  v_and_b32_dpp v35, v76, v5 row_newbcast:11 row_mask:0xf bank_mask:0xf
  v_mfma_f32_16x16x32_bf16 v[40:43], a[40:43], v[28:31], v[40:43]
  v_and_b32_dpp v28, v76, v2 row_newbcast:12 row_mask:0xf bank_mask:0xf
  v_and_b32_dpp v29, v76, v3 row_newbcast:12 row_mask:0xf bank_mask:0xf
  v_and_b32_dpp v30, v76, v4 row_newbcast:12 row_mask:0xf bank_mask:0xf
  v_and_b32_dpp v31, v76, v5 row_newbcast:12 row_mask:0xf bank_mask:0xf
  v_mfma_f32_16x16x32_bf16 v[40:43], a[44:47], v[32:35], v[40:43]
  v_and_b32_dpp v32, v76, v2 row_newbcast:13 row_mask:0xf bank_mask:0xf
  v_and_b32_dpp v33, v76, v3 row_newbcast:13 row_mask:0xf bank_mask:0xf
  v_and_b32_dpp v34, v76, v4 row_newbcast:13 row_mask:0xf bank_mask:0xf
  v_and_b32_dpp v35, v76, v5 row_newbcast:13 row_mask:0xf bank_mask:0xf
  v_mfma_f32_16x16x32_bf16 v[40:43], a[48:51], v[28:31], v[40:43]
  v_and_b32_dpp v28, v76, v2 row_newbcast:14 row_mask:0xf bank_mask:0xf
  v_and_b32_dpp v29, v76, v3 row_newbcast:14 row_mask:0xf bank_mask:0xf
  v_and_b32_dpp v30, v76, v4 row_newbcast:14 row_mask:0xf bank_mask:0xf
  v_and_b32_dpp v31, v76, v5 row_newbcast:14 row_mask:0xf bank_mask:0xf
  v_mfma_f32_16x16x32_bf16 v[40:43], a[52:55], v[32:35], v[40:43]
  v_and_b32_dpp v32, v76, v2 row_newbcast:15 row_mask:0xf bank_mask:0xf
  v_and_b32_dpp v33, v76, v3 row_newbcast:15 row_mask:0xf bank_mask:0xf
  v_and_b32_dpp v34, v76, v4 row_newbcast:15 row_mask:0xf bank_mask:0xf
  v_and_b32_dpp v35, v76, v5 row_newbcast:15 row_mask:0xf bank_mask:0xf
  v_mfma_f32_16x16x32_bf16 v[40:43], a[56:59], v[28:31], v[40:43]
  v_and_b32_dpp v28, v77, v2 row_newbcast:0 row_mask:0xf bank_mask:0xf
  v_and_b32_dpp v29, v77, v3 row_newbcast:0 row_mask:0xf bank_mask:0xf
  v_and_b32_dpp v30, v77, v4 row_newbcast:0 row_mask:0xf bank_mask:0xf
  v_and_b32_dpp v31, v77, v5 row_newbcast:0 row_mask:0xf bank_mask:0xf
  v_mfma_f32_16x16x32_bf16 v[40:43], a[60:63], v[32:35], v[40:43]
  v_and_b32_dpp v32, v77, v2 row_newbcast:1 row_mask:0xf bank_mask:0xf
  v_and_b32_dpp v33, v77, v3 row_newbcast:1 row_mask:0xf bank_mask:0xf
  v_and_b32_dpp v34, v77, v4 row_newbcast:1 row_mask:0xf bank_mask:0xf
  v_and_b32_dpp v35, v77, v5 row_newbcast:1 row_mask:0xf bank_mask:0xf
  v_mfma_f32_16x16x32_bf16 v[40:43], a[64:67], v[28:31], v[40:43]
  v_and_b32_dpp v28, v77, v2 row_newbcast:2 row_mask:0xf bank_mask:0xf
  v_and_b32_dpp v29, v77, v3 row_newbcast:2 row_mask:0xf bank_mask:0xf
  v_and_b32_dpp v30, v77, v4 row_newbcast:2 row_mask:0xf bank_mask:0xf
  v_and_b32_dpp v31, v77, v5 row_newbcast:2 row_mask:0xf bank_mask:0xf
  v_mfma_f32_16x16x32_bf16 v[40:43], a[68:71], v[32:35], v[40:43]
  v_and_b32_dpp v32, v77, v2 row_newbcast:3 row_mask:0xf bank_mask:0xf
  v_and_b32_dpp v33, v77, v3 row_newbcast:3 row_mask:0xf bank_mask:0xf
  v_and_b32_dpp v34, v77, v4 row_newbcast:3 row_mask:0xf bank_mask:0xf
  v_and_b32_dpp v35, v77, v5 row_newbcast:3 row_mask:0xf bank_mask:0xf
  v_mfma_f32_16x16x32_bf16 v[40:43], a[72:75], v[28:31], v[40:43]
  v_and_b32_dpp v28, v77, v2 row_newbcast:4 row_mask:0xf bank_mask:0xf
  v_and_b32_dpp v29, v77, v3 row_newbcast:4 row_mask:0xf bank_mask:0xf
  v_and_b32_dpp v30, v77, v4 row_newbcast:4 row_mask:0xf bank_mask:0xf
  v_and_b32_dpp v31, v77, v5 row_newbcast:4 row_mask:0xf bank_mask:0xf
  v_mfma_f32_16x16x32_bf16 v[40:43], a[76:79], v[32:35], v[40:43]
  v_and_b32_dpp v32, v77, v2 row_newbcast:5 row_mask:0xf bank_mask:0xf
  v_and_b32_dpp v33, v77, v3 row_newbcast:5 row_mask:0xf bank_mask:0xf
  v_and_b32_dpp v34, v77, v4 row_newbcast:5 row_mask:0xf bank_mask:0xf
  v_and_b32_dpp v35, v77, v5 row_newbcast:5 row_mask:0xf bank_mask:0xf
  v_mfma_f32_16x16x32_bf16 v[40:43], a[80:83], v[28:31], v[40:43]
  v_and_b32_dpp v28, v77, v2 row_newbcast:6 row_mask:0xf bank_mask:0xf
  v_and_b32_dpp v29, v77, v3 row_newbcast:6 row_mask:0xf bank_mask:0xf
  v_and_b32_dpp v30, v77, v4 row_newbcast:6 row_mask:0xf bank_mask:0xf
  v_and_b32_dpp v31, v77, v5 row_newbcast:6 row_mask:0xf bank_mask:0xf
  v_mfma_f32_16x16x32_bf16 v[40:43], a[84:87], v[32:35], v[40:43]
  v_and_b32_dpp v32, v77, v2 row_newbcast:7 row_mask:0xf bank_mask:0xf
  v_and_b32_dpp v33, v77, v3 row_newbcast:7 row_mask:0xf bank_mask:0xf
  v_and_b32_dpp v34, v77, v4 row_newbcast:7 row_mask:0xf bank_mask:0xf
  v_and_b32_dpp v35, v77, v5 row_newbcast:7 row_mask:0xf bank_mask:0xf
  v_mfma_f32_16x16x32_bf16 v[40:43], a[88:91], v[28:31], v[40:43]
  v_and_b32_dpp v28, v77, v2 row_newbcast:8 row_mask:0xf bank_mask:0xf
  v_and_b32_dpp v29, v77, v3 row_newbcast:8 row_mask:0xf bank_mask:0xf
  v_and_b32_dpp v30, v77, v4 row_newbcast:8 row_mask:0xf bank_mask:0xf
  v_and_b32_dpp v31, v77, v5 row_newbcast:8 row_mask:0xf bank_mask:0xf
  v_mfma_f32_16x16x32_bf16 v[40:43], a[92:95], v[32:35], v[40:43]
  v_and_b32_dpp v32, v77, v2 row_newbcast:9 row_mask:0xf bank_mask:0xf
  v_and_b32_dpp v33, v77, v3 row_newbcast:9 row_mask:0xf bank_mask:0xf
  v_and_b32_dpp v34, v77, v4 row_newbcast:9 row_mask:0xf bank_mask:0xf
  v_and_b32_dpp v35, v77, v5 row_newbcast:9 row_mask:0xf bank_mask:0xf
  v_mfma_f32_16x16x32_bf16 v[40:43], a[96:99], v[28:31], v[40:43]
  v_and_b32_dpp v28, v77, v2 row_newbcast:10 row_mask:0xf bank_mask:0xf
  v_and_b32_dpp v29, v77, v3 row_newbcast:10 row_mask:0xf bank_mask:0xf
  v_and_b32_dpp v30, v77, v4 row_newbcast:10 row_mask:0xf bank_mask:0xf
  v_and_b32_dpp v31, v77, v5 row_newbcast:10 row_mask:0xf bank_mask:0xf
  v_mfma_f32_16x16x32_bf16 v[40:43], a[100:103], v[32:35], v[40:43]
  v_and_b32_dpp v32, v77, v2 row_newbcast:11 row_mask:0xf bank_mask:0xf
  v_and_b32_dpp v33, v77, v3 row_newbcast:11 row_mask:0xf bank_mask:0xf
  v_and_b32_dpp v34, v77, v4 row_newbcast:11 row_mask:0xf bank_mask:0xf
  v_and_b32_dpp v35, v77, v5 row_newbcast:11 row_mask:0xf bank_mask:0xf
  v_mfma_f32_16x16x32_bf16 v[40:43], a[104:107], v[28:31], v[40:43]
  v_and_b32_dpp v28, v77, v2 row_newbcast:12 row_mask:0xf bank_mask:0xf
  v_and_b32_dpp v29, v77, v3 row_newbcast:12 row_mask:0xf bank_mask:0xf
  v_and_b32_dpp v30, v77, v4 row_newbcast:12 row_mask:0xf bank_mask:0xf
  v_and_b32_dpp v31, v77, v5 row_newbcast:12 row_mask:0xf bank_mask:0xf
  v_mfma_f32_16x16x32_bf16 v[40:43], a[108:111], v[32:35], v[40:43]
  v_and_b32_dpp v32, v77, v2 row_newbcast:13 row_mask:0xf bank_mask:0xf
  v_and_b32_dpp v33, v77, v3 row_newbcast:13 row_mask:0xf bank_mask:0xf
  v_and_b32_dpp v34, v77, v4 row_newbcast:13 row_mask:0xf bank_mask:0xf
  v_and_b32_dpp v35, v77, v5 row_newbcast:13 row_mask:0xf bank_mask:0xf
  v_mfma_f32_16x16x32_bf16 v[40:43], a[112:115], v[28:31], v[40:43]
  v_and_b32_dpp v28, v77, v2 row_newbcast:14 row_mask:0xf bank_mask:0xf
  v_and_b32_dpp v29, v77, v3 row_newbcast:14 row_mask:0xf bank_mask:0xf
  v_and_b32_dpp v30, v77, v4 row_newbcast:14 row_mask:0xf bank_mask:0xf
  v_and_b32_dpp v31, v77, v5 row_newbcast:14 row_mask:0xf bank_mask:0xf
  v_mfma_f32_16x16x32_bf16 v[40:43], a[116:119], v[32:35], v[40:43]
  v_and_b32_dpp v32, v77, v2 row_newbcast:15 row_mask:0xf bank_mask:0xf
  v_and_b32_dpp v33, v77, v3 row_newbcast:15 row_mask:0xf bank_mask:0xf
  v_and_b32_dpp v34, v77, v4 row_newbcast:15 row_mask:0xf bank_mask:0xf
  v_and_b32_dpp v35, v77, v5 row_newbcast:15 row_mask:0xf bank_mask:0xf
  v_mfma_f32_16x16x32_bf16 v[40:43], a[120:123], v[28:31], v[40:43]
  s_nop 1
  v_mfma_f32_16x16x32_bf16 v[40:43], a[124:127], v[32:35], v[40:43]
  s_nop 7
  v_cndmask_b32 v40, v40, 1.0, s[100:101]
  v_cndmask_b32 v41, v41, 1.0, s[100:101]
  v_cndmask_b32 v42, v42, 1.0, s[100:101]
  v_cndmask_b32 v43, v43, 1.0, s[100:101]
  v_mov_b32 v64, v40
  v_mov_b32 v65, v41
  v_mov_b32 v66, v42
  v_mov_b32 v67, v43
  s_mov_b32 exec_lo, 0x01ff01ff
  s_mov_b32 exec_hi, 0x01ff01ff
  buffer_atomic_add_f32 v40, v60, s[52:55], 0 offen offset:0 sc0
  buffer_atomic_add_f32 v41, v60, s[52:55], 0 offen offset:64 sc0
  buffer_atomic_add_f32 v42, v60, s[52:55], 0 offen offset:128 sc0
  buffer_atomic_add_f32 v43, v60, s[52:55], 0 offen offset:192 sc0
  s_mov_b64 exec, -1
  s_waitcnt vmcnt(0)
  v_add_f32 v116, v116, v106
  v_add_f32 v117, v117, v107
  v_add_f32 v118, v118, v108
  v_add_f32 v119, v119, v109
  s_nop 0
  v_mov_b32_dpp v68, v40 row_newbcast:8 row_mask:0xf bank_mask:0xf
  v_mov_b32_dpp v69, v41 row_newbcast:8 row_mask:0xf bank_mask:0xf
  v_mov_b32_dpp v70, v42 row_newbcast:8 row_mask:0xf bank_mask:0xf
  v_mov_b32_dpp v71, v43 row_newbcast:8 row_mask:0xf bank_mask:0xf
  s_mov_b32 s74, 0x427c0000
  v_cmp_gt_u32 s[4:5], 8, v45
  v_cmp_eq_f32 s[6:7], s74, v68
  v_cmp_eq_f32 s[8:9], s74, v69
  v_cmp_eq_f32 s[10:11], s74, v70
  v_cmp_eq_f32 s[12:13], s74, v71
  s_nop 1
  s_and_b64 s[6:7], s[6:7], s[4:5]
  s_and_b64 s[8:9], s[8:9], s[4:5]
  s_and_b64 s[10:11], s[10:11], s[4:5]
  s_and_b64 s[12:13], s[12:13], s[4:5]
  s_or_b64 s[14:15], s[6:7], s[8:9]
  s_or_b64 s[16:17], s[10:11], s[12:13]
  s_or_b64 s[14:15], s[14:15], s[16:17]
  s_cmp_eq_u64 s[14:15], 0
  s_cbranch_scc1 L_fin
L_fchk:
  v_mov_b32_dpp v68, v116 row_newbcast:8 row_mask:0xf bank_mask:0xf
  v_mov_b32_dpp v69, v117 row_newbcast:8 row_mask:0xf bank_mask:0xf
  v_mov_b32_dpp v70, v118 row_newbcast:8 row_mask:0xf bank_mask:0xf
  v_mov_b32_dpp v71, v119 row_newbcast:8 row_mask:0xf bank_mask:0xf
  s_mov_b32 s74, 0x42800000
  v_cmp_neq_f32 s[16:17], s74, v68
  s_nop 1
  s_and_b64 s[16:17], s[16:17], s[6:7]
  s_mov_b64 s[18:19], s[16:17]
  v_cmp_neq_f32 s[16:17], s74, v69
  s_nop 1
  s_and_b64 s[16:17], s[16:17], s[8:9]
  s_or_b64 s[18:19], s[18:19], s[16:17]
  v_cmp_neq_f32 s[16:17], s74, v70
  s_nop 1
  s_and_b64 s[16:17], s[16:17], s[10:11]
  s_or_b64 s[18:19], s[18:19], s[16:17]
  v_cmp_neq_f32 s[16:17], s74, v71
  s_nop 1
  s_and_b64 s[16:17], s[16:17], s[12:13]
  s_or_b64 s[18:19], s[18:19], s[16:17]
  s_cmp_eq_u64 s[18:19], 0
  s_cbranch_scc1 L_fok
  s_mov_b32 s74, 16384
  v_mov_b32 v116, 0
  v_mov_b32 v117, 0
  v_mov_b32 v118, 0
  v_mov_b32 v119, 0
  s_mov_b32 exec_lo, 0x01ff01ff
  s_mov_b32 exec_hi, 0x01ff01ff
  buffer_atomic_add_f32 v116, v60, s[52:55], s74 offen offset:0 sc0
  buffer_atomic_add_f32 v117, v60, s[52:55], s74 offen offset:64 sc0
  buffer_atomic_add_f32 v118, v60, s[52:55], s74 offen offset:128 sc0
  buffer_atomic_add_f32 v119, v60, s[52:55], s74 offen offset:192 sc0
  s_waitcnt vmcnt(0)
  s_mov_b64 exec, -1
  s_branch L_fchk
L_fok:
  v_add_f32 v40, v40, v64
  v_add_f32 v41, v41, v65
  v_add_f32 v42, v42, v66
  v_add_f32 v43, v43, v67
  v_cvt_pk_bf16_f32 v40, v40, v40
  v_and_b32 v40, 0xffff0000, v40
  v_cvt_pk_bf16_f32 v41, v41, v41
  v_and_b32 v41, 0xffff0000, v41
  v_cvt_pk_bf16_f32 v42, v42, v42
  v_and_b32 v42, 0xffff0000, v42
  v_cvt_pk_bf16_f32 v43, v43, v43
  v_and_b32 v43, 0xffff0000, v43
  v_cvt_pk_bf16_f32 v116, v116, v116
  v_and_b32 v116, 0xffff0000, v116
  v_cvt_pk_bf16_f32 v117, v117, v117
  v_and_b32 v117, 0xffff0000, v117
  v_cvt_pk_bf16_f32 v118, v118, v118
  v_and_b32 v118, 0xffff0000, v118
  v_cvt_pk_bf16_f32 v119, v119, v119
  v_and_b32 v119, 0xffff0000, v119
  v_lshlrev_b32 v112, 16, v112
  v_lshlrev_b32 v113, 16, v113
  v_lshlrev_b32 v114, 16, v114
  v_lshlrev_b32 v115, 16, v115
  v_add_f32 v40, v112, v40
  v_add_f32 v41, v113, v41
  v_add_f32 v42, v114, v42
  v_add_f32 v43, v115, v43
  v_cvt_pk_bf16_f32 v40, v40, v40
  v_and_b32 v40, 0xffff0000, v40
  v_cvt_pk_bf16_f32 v41, v41, v41
  v_and_b32 v41, 0xffff0000, v41
  v_cvt_pk_bf16_f32 v42, v42, v42
  v_and_b32 v42, 0xffff0000, v42
  v_cvt_pk_bf16_f32 v43, v43, v43
  v_and_b32 v43, 0xffff0000, v43
  v_add_f32 v40, v40, v116
  v_add_f32 v41, v41, v117
  v_add_f32 v42, v42, v118
  v_add_f32 v43, v43, v119
  v_cvt_pk_bf16_f32 v40, v40, v40
  v_cvt_pk_bf16_f32 v41, v41, v41
  v_cvt_pk_bf16_f32 v42, v42, v42
  v_cvt_pk_bf16_f32 v43, v43, v43
  s_mov_b64 exec, s[6:7]
  s_cbranch_execz L_skip0
  buffer_store_short v40, v62, s[60:63], 0 offen offset:0
L_skip0:
  s_mov_b64 exec, s[8:9]
  s_cbranch_execz L_skip1
  buffer_store_short v41, v62, s[60:63], 0 offen offset:16
L_skip1:
  s_mov_b64 exec, s[10:11]
  s_cbranch_execz L_skip2
  buffer_store_short v42, v62, s[60:63], 0 offen offset:32
L_skip2:
  s_mov_b64 exec, s[12:13]
  s_cbranch_execz L_skip3
  buffer_store_short v43, v62, s[60:63], 0 offen offset:48
L_skip3:
L_fin:
L_end:
  s_endpgm
.section .rodata,"a"
.p2align 6
.amdhsa_kernel parallel_sum__mha_block_cached__dense_activation_silu__decode_kernel
  .amdhsa_next_free_vgpr 512
  .amdhsa_next_free_sgpr 102
  .amdhsa_accum_offset 256
  .amdhsa_group_segment_fixed_size 0
  .amdhsa_kernarg_size 88
  .amdhsa_user_sgpr_count 2
  .amdhsa_user_sgpr_kernarg_segment_ptr 1
  .amdhsa_system_sgpr_workgroup_id_x 1
.end_amdhsa_kernel
```
